```python
import torch

def _softmax(x, axis=-1):
    return torch.softmax(x, dim=axis)
def _gelu(x):
    return torch.nn.functional.gelu(x, approximate="tanh")
def _silu(x):
    return torch.nn.functional.silu(x)
def _sigmoid(x):
    return torch.sigmoid(x)
def _layernorm(x, axis=-1, eps=1e-5):
    m = x.mean(dim=axis, keepdim=True)
    v = x.var(dim=axis, keepdim=True, unbiased=False)
    return (x - m) / torch.sqrt(v + eps)
def _scatter_add(tgt, idx, src, axis=0):
    return tgt.clone().index_add_(axis, idx, src)
def _segment_sum(src, seg, n):
    out = torch.zeros((n,) + src.shape[1:], dtype=src.dtype)
    return out.index_add_(0, seg, src)
def _pad(x, pw):
    flat = tuple(v for pair in reversed(pw) for v in pair)
    return torch.nn.functional.pad(x, flat)

kernel_name = 'sequential_preLN__ssm_conv_s4__glu_gated_bilinear__prompt'

def setup_inputs():

    _w = (lambda a: (lambda t: t.to(torch.bfloat16) if t.is_floating_point() else t)(torch.as_tensor(a)))
    def _A_setup():
        B, L, D, N = 1, 2048, 512, 128
        A_re = -(lambda _x: torch.exp(torch.as_tensor(_x)))((lambda *s: torch.randn(*s, dtype=torch.bfloat16) * 6.4)(D, N))
        A_im = torch.pi * (lambda *s: torch.randn(*s, dtype=torch.bfloat16) * 0.05)(D, N)
        B_re = (lambda *s: torch.randn(*s, dtype=torch.bfloat16) * 0.1)(D, N)
        B_im = (lambda *s: torch.randn(*s, dtype=torch.bfloat16) * 0.1)(D, N)
        C_re = (lambda *s: torch.randn(*s, dtype=torch.bfloat16) * 0.1)(D, N)
        C_im = (lambda *s: torch.randn(*s, dtype=torch.bfloat16) * 0.1)(D, N)
        log_dt = (lambda *s: torch.randn(*s, dtype=torch.bfloat16) * 0.05)(D) * 0.5 - 4.0
        Dskip = (lambda *s: torch.randn(*s, dtype=torch.bfloat16) * 0.05)(D)
        return {
            "u": _w((lambda *s: torch.randn(*s, dtype=torch.bfloat16) * 0.05)(B, L, D)),
            "A_re": _w(A_re),
            "A_im": _w(A_im),
            "B_re": _w(B_re),
            "B_im": _w(B_im),
            "C_re": _w(C_re),
            "C_im": _w(C_im),
            "log_dt": _w(log_dt),
            "Dskip": _w(Dskip),
        }
    _A_in = _A_setup()

    def _B_setup():
        B, S, D, F = 1, 2048, 512, 1792
        return {
            "x": _w((lambda *s: torch.randn(*s, dtype=torch.bfloat16) * 0.05)(B, S, D)),
            "w_gate": _w((lambda *s: torch.randn(*s, dtype=torch.bfloat16) * 0.4)(D, F) * (D ** -0.5)),
            "w_up": _w((lambda *s: torch.randn(*s, dtype=torch.bfloat16) * 0.4)(D, F) * (D ** -0.5)),
            "w_down": _w((lambda *s: torch.randn(*s, dtype=torch.bfloat16) * 0.4)(F, D) * (F ** -0.5)),
        }
    _B_in = _B_setup()

    return {
        "A_u": _A_in["u"],
        "A_A_re": _A_in["A_re"],
        "A_A_im": _A_in["A_im"],
        "A_B_re": _A_in["B_re"],
        "A_B_im": _A_in["B_im"],
        "A_C_re": _A_in["C_re"],
        "A_C_im": _A_in["C_im"],
        "A_log_dt": _A_in["log_dt"],
        "A_Dskip": _A_in["Dskip"],
        "B_x": _B_in["x"],
        "B_w_gate": _B_in["w_gate"],
        "B_w_up": _B_in["w_up"],
        "B_w_down": _B_in["w_down"],
    }

def reference(A_u, A_A_re, A_A_im, A_B_re, A_B_im, A_C_re, A_C_im, A_log_dt, A_Dskip, B_x, B_w_gate, B_w_up, B_w_down):
    def _A_ref(u, A_re, A_im, B_re, B_im, C_re, C_im, log_dt, Dskip):
        Bsz, L, D = u.shape
        dt = torch.exp(log_dt)[:, None]
        A = A_re + 1j * A_im
        Bc = B_re + 1j * B_im
        Cc = C_re + 1j * C_im
        logdA = dt * A
        dB = dt * Bc
        l = (lambda x, dt: x.to(dt))(torch.arange(L), A_re.dtype)
        P = torch.exp(logdA[:, :, None] * l[None, None, :])
        K = torch.einsum("dn,dnl,dn->dl", Cc, P, dB).real
        L2 = 2 * L
        Kp = _pad(K, ((0, 0), (0, L)))
        up = (lambda x, *d: x.permute(*d))(u, 0, 2, 1)
        up = _pad(up, ((0, 0), (0, 0), (0, L)))
        Kf = (lambda x, axes=(-2,-1): torch.fft.rfft2(x.float(), dim=axes))(Kp[:, None, :], axes=(-2, -1))
        Uf = (lambda x, axes=(-2,-1): torch.fft.rfft2(x.float(), dim=axes))(up[:, :, None, :], axes=(-2, -1))
        Yf = Uf * Kf[None, :, :, :]
        y = (lambda x, s, axes=(-2,-1): torch.fft.irfft2(x, s=s, dim=axes).to(torch.bfloat16))(Yf, (1, L2), axes=(-2, -1))[:, :, 0, :L]
        y = (lambda x, *d: x.permute(*d))(y, 0, 2, 1) + u * Dskip[None, None, :]
        return y

    def _B_ref(x, w_gate, w_up, w_down):
        g = torch.einsum("bsd,df->bsf", x, w_gate)
        u = torch.einsum("bsd,df->bsf", x, w_up)
        h = g * u
        return torch.einsum("bsf,fd->bsd", h, w_down)

    x = A_u
    h = x + _A_ref(_layernorm(x, axis=-1), A_A_re, A_A_im, A_B_re, A_B_im, A_C_re, A_C_im, A_log_dt, A_Dskip)
    h2 = h + _B_ref(_layernorm(h, axis=-1), B_w_gate, B_w_up, B_w_down)
    return h2
```

```asm
; @launch grid=(256,1,1) block=(512,1,1) lds=163840
.amdgcn_target "amdgcn-amd-amdhsa--gfx950"
.text
.globl sequential_preLN__ssm_conv_s4__glu_gated_bilinear__prompt_kernel
.p2align 8
.type sequential_preLN__ssm_conv_s4__glu_gated_bilinear__prompt_kernel,@function
sequential_preLN__ssm_conv_s4__glu_gated_bilinear__prompt_kernel:
    s_cmp_ge_u32 s2, 256
    s_cbranch_scc1 L_exit
    s_load_dwordx16 s[8:23], s[0:1], 0
    s_load_dwordx16 s[24:39], s[0:1], 64
    v_readfirstlane_b32 s4, v0
    v_and_b32 v1, 63, v0
    s_nop 0
    s_lshr_b32 s4, s4, 6
    s_cmp_lt_u32 s4, 4
    s_cbranch_scc1 L_c
    s_getpc_b64 s[6:7]
L_pc_k:
    s_sub_u32 s6, s6, L_pc_k - sequential_preLN__ssm_conv_s4__glu_gated_bilinear__prompt_kernel
    s_subb_u32 s7, s7, 0
    s_lshr_b32 s3, s2, 1
    s_and_b32 s3, s3, 0x7c
    s_add_u32 s3, s3, s4
    s_sub_u32 s3, s3, 4
    s_min_u32 s3, s3, (L_end_k - sequential_preLN__ssm_conv_s4__glu_gated_bilinear__prompt_kernel) / 1024 - 1
    s_lshl_b32 s3, s3, 10
    v_lshl_add_u32 v2, v1, 4, s3
    global_load_dwordx4 v[252:255], v2, s[6:7]
    v_and_b32 v3, 255, v0
    v_lshlrev_b32 v5, 1, v3
    s_lshl_b32 s3, s2, 9
    v_add_u32 v5, s3, v5
    v_lshrrev_b32 v4, 7, v3
    v_lshl_add_u32 v4, s2, 1, v4
    v_lshlrev_b32 v4, 1, v4
    v_mov_b32 v24, 0
    v_mov_b32 v25, 0
    v_mov_b32 v26, 0
    v_mov_b32 v27, 0
    v_mov_b32 v28, 0
    v_mov_b32 v29, 0
    v_mov_b32 v30, 0
    s_waitcnt lgkmcnt(0)
    global_load_short_d16_hi v24, v4, s[22:23]
    global_load_short_d16_hi v25, v5, s[10:11]
    global_load_short_d16_hi v26, v5, s[12:13]
    global_load_short_d16_hi v27, v5, s[14:15]
    global_load_short_d16_hi v28, v5, s[16:17]
    global_load_short_d16_hi v29, v5, s[18:19]
    global_load_short_d16_hi v30, v5, s[20:21]
    s_barrier
    s_branch L_h
L_c:
    s_and_b32 s56, s2, 7
    s_lshr_b32 s57, s2, 3
    s_lshl_b32 s63, s56, 5
    s_add_u32 s63, s63, s57
    v_lshrrev_b32 v30, 5, v0
    v_and_b32 v2, 31, v1
    v_lshlrev_b32 v22, 10, v30
    v_lshl_add_u32 v22, v2, 4, v22
    s_lshl_b32 s54, s63, 13
    s_and_b32 s58, s57, 3
    s_lshl_b32 s3, s56, 2
    s_add_u32 s58, s58, s3
    s_lshr_b32 s59, s57, 2
    v_and_b32 v6, 7, v0
    v_lshrrev_b32 v7, 3, v0
    v_lshlrev_b32 v20, 13, v6
    v_lshl_add_u32 v20, v7, 2, v20
    s_lshl_b32 s60, s58, 16
    s_lshl_b32 s3, s59, 7
    s_add_u32 s60, s60, s3
    s_add_u32 s61, s60, 4096
    v_mov_b32 v24, 0
    v_mov_b32 v25, 0
    v_mov_b32 v31, 0x27400
    v_lshl_add_u32 v31, v1, 2, v31
    ds_write_b32 v31, v24
    s_waitcnt lgkmcnt(0)
    s_mov_b32 s44, s8
    s_and_b32 s45, s9, 0xffff
    s_mov_b32 s46, 0x200000
    s_mov_b32 s47, 0x20000
    buffer_load_dwordx4 v[112:115], v22, s[44:47], s54 offen offset:0
    buffer_load_dwordx4 v[116:119], v22, s[44:47], s54 offen offset:512
    buffer_load_dword v8, v20, s[44:47], s60 offen offset:0
    buffer_load_dword v9, v20, s[44:47], s60 offen offset:1024
    buffer_load_dword v10, v20, s[44:47], s60 offen offset:2048
    buffer_load_dword v11, v20, s[44:47], s60 offen offset:3072
    buffer_load_dword v12, v20, s[44:47], s61 offen offset:0
    buffer_load_dword v13, v20, s[44:47], s61 offen offset:1024
    buffer_load_dword v14, v20, s[44:47], s61 offen offset:2048
    buffer_load_dword v15, v20, s[44:47], s61 offen offset:3072
    s_load_dword s5, s[38:39], 0
    s_lshl_b32 s3, s2, 2
    s_load_dword s55, s[24:25], s3
    s_min_u32 s6, s2, 223
    s_cmp_ge_u32 s6, 112
    s_cselect_b32 s7, 112, 0
    s_cselect_b32 s48, s30, s28
    s_cselect_b32 s49, s31, s29
    s_cselect_b32 s68, 14336, 0
    s_cselect_b32 s64, 16384, 0
    s_sub_u32 s6, s6, s7
    s_and_b32 s49, s49, 0xffff
    s_mov_b32 s50, 0x1c0000
    s_mov_b32 s51, 0x20000
    s_and_b32 s7, s6, 3
    s_lshr_b32 s6, s6, 2
    s_lshl_b32 s67, s7, 2
    s_add_u32 s67, s67, s4
    s_lshl_b32 s3, s67, 10
    s_add_u32 s64, s64, s3
    s_lshl_b32 s3, s6, 17
    s_add_u32 s64, s64, s3
    s_add_u32 s64, s64, 0xb00000
    s_mul_i32 s67, s67, 114688
    s_lshl_b32 s3, s6, 7
    s_add_u32 s67, s67, s3
    s_mul_i32 s7, s7, 28672
    s_add_u32 s68, s68, s7
    s_lshl_b32 s3, s6, 9
    s_add_u32 s68, s68, s3
    s_add_u32 s68, s68, 0x20000
    s_cmp_lt_u32 s6, 16
    s_cselect_b32 s64, -1, s64
    s_cmp_ge_u32 s2, 224
    s_cselect_b32 s64, -1, s64
    v_bfe_u32 v240, v1, 1, 3
    v_mul_u32_u24 v240, 3584, v240
    v_lshrrev_b32 v241, 4, v1
    v_lshl_add_u32 v240, v241, 5, v240
    v_and_b32 v242, 1, v1
    v_lshl_add_u32 v240, v242, 4, v240
    v_and_b32 v242, 15, v1
    v_lshlrev_b32 v242, 4, v242
    v_lshl_add_u32 v241, v241, 15, v242
    s_barrier
    buffer_load_dwordx4 v[224:227], v240, s[48:51], s67 offen
    s_add_u32 s67, s67, 28672
    buffer_load_dwordx4 v[228:231], v240, s[48:51], s67 offen
    s_add_u32 s67, s67, 28672
    buffer_load_dwordx4 v[232:235], v240, s[48:51], s67 offen
    s_add_u32 s67, s67, 28672
    buffer_load_dwordx4 v[236:239], v240, s[48:51], s67 offen
    s_mov_b32 s40, s38
    s_and_b32 s41, s39, 0xffff
    s_mov_b32 s42, 0xe80000
    s_mov_b32 s43, 0x20000
    v_lshlrev_b32 v21, 13, v7
    v_lshl_add_u32 v21, v6, 4, v21
    s_lshl_b32 s60, s59, 18
    s_lshl_b32 s3, s58, 8
    s_add_u32 s60, s60, s3
    s_add_u32 s60, s60, 0x80000
    v_mul_u32_u24 v124, 43, v30
    v_lshrrev_b32 v124, 7, v124
    v_add_lshl_u32 v124, v30, v124, 2
    v_add_u32 v124, 0x10800, v124
    v_lshlrev_b32 v243, 4, v1
    v_add_u32 v125, 0x10800, v243
    s_lshl_b32 s53, s63, 7
    s_add_u32 s53, s53, 0x8000
    v_mov_b32 v120, 0
    v_mov_b32 v121, 0
    v_mov_b32 v122, 0
    v_mov_b32 v123, 0
    v_mov_b32 v16, 0x10880
    v_lshl_add_u32 v16, v7, 2, v16
    v_bfe_u32 v17, v1, 3, 1
    v_mul_u32_u24 v17, 32640, v17
    v_add_u32 v17, v17, v243
    v_lshrrev_b32 v18, 2, v7
    v_lshlrev_b32 v18, 12, v18
    v_and_b32 v19, 3, v7
    v_lshl_add_u32 v18, v19, 7, v18
    s_lshr_b32 s52, s2, 5
    s_lshl_b32 s52, s52, 9
    s_and_b32 s3, s2, 31
    s_lshl_b32 s3, s3, 2
    s_add_u32 s52, s52, s3
    s_add_u32 s52, s52, 0x10000
    s_mov_b32 s3, 0x9e3779b1
    v_mul_lo_u32 v126, v6, s3
    s_and_b32 s56, s4, 1
    s_cmp_ge_u32 s4, 2
    s_cbranch_scc1 L_padk
    s_mul_i32 s3, s56, 4608
    s_add_u32 s3, s3, 107008
    v_lshl_add_u32 v27, v1, 3, s3
    ds_write_b64 v27, v[24:25]
    s_branch L_padj
L_padk:
    v_lshrrev_b32 v27, 4, v1
    v_mul_u32_u24 v27, 4160, v27
    v_and_b32 v28, 15, v1
    v_lshl_add_u32 v27, v28, 2, v27
    s_mul_i32 s3, s56, 16640
    s_add_u32 s3, s3, 73728
    v_add_u32 v27, s3, v27
    s_mov_b32 exec_lo, 0x00ff00ff
    s_mov_b32 exec_hi, 0x07ff00ff
    ds_write_b32 v27, v24
    s_mov_b64 exec, -1
L_padj:
    v_lshlrev_b32 v2, 8, v7
    v_lshl_add_u32 v2, v6, 4, v2
    v_lshrrev_b32 v22, 2, v1
    v_lshlrev_b32 v3, 7, v22
    v_and_b32 v26, 3, v1
    v_lshl_add_u32 v3, v26, 4, v3
    s_lshl_b32 s57, s4, 13
    s_add_u32 s57, s57, 0x8000
    s_add_u32 s58, s57, 4096
    s_lshl_b32 s54, s2, 13
    s_add_u32 s54, s54, 0x80000
    s_lshr_b32 s61, s4, 1
    v_bfe_u32 v27, v1, 2, 2
    v_mul_u32_u24 v4, 4160, v27
    v_cmp_eq_u32 vcc, 3, v27
    s_lshl_b32 s63, s56, 8
    v_lshrrev_b32 v28, 5, v1
    v_cndmask_b32 v27, 0, 8, vcc
    v_add_u32 v4, v4, v27
    v_lshl_add_u32 v4, v26, 3, v4
    v_lshlrev_b32 v28, 5, v28
    v_and_b32 v29, 16, v1
    v_add_u32 v4, v4, v28
    v_sub_u32 v4, v4, v29
    s_mul_i32 s62, s61, 16640
    s_add_u32 s62, s62, s63
    s_add_u32 s62, s62, 73752
    v_add_u32 v4, s62, v4
    v_and_b32 v5, 15, v1
    v_lshlrev_b32 v5, 5, v5
    v_sub_u32 v5, v5, v28
    v_add_u32 v5, v5, v29
    s_mul_i32 s62, s61, 4608
    s_add_u32 s62, s62, 107328
    s_sub_u32 s62, s62, s63
    v_add_u32 v5, s62, v5
    s_lshl_b32 s62, s4, 13
    s_add_u32 s62, s62, 116224
    v_add_u32 v6, s62, v243
    v_mul_u32_u24 v23, 80, v1
    v_add_u32 v23, s62, v23
    v_mul_u32_u24 v22, 80, v22
    v_lshl_add_u32 v22, v26, 4, v22
    v_add_u32 v22, s62, v22
    v_mov_b32 v7, 0x12000
    v_lshl_add_u32 v7, v0, 4, v7
    s_mov_b32 s59, 0xffff0000
    s_mov_b32 s69, 0
    s_waitcnt lgkmcnt(0)
    s_mul_i32 s5, s5, 0x9e3779b1
    s_add_u32 s5, s5, 0x7f4a7c15
    s_mov_b32 s0, 0
    v_xor_b32 v126, s5, v126
    s_mov_b32 s3, 0x85ebca6b
    v_mul_lo_u32 v126, v126, s3
    v_lshrrev_b32 v127, 15, v126
    v_xor_b32 v126, v126, v127
    v_mov_b32 v244, -1
    v_mov_b32 v245, -1
    v_mov_b32 v246, -1
    v_mov_b32 v247, -1
    v_mov_b32 v248, s5
    v_mov_b32 v249, s5
    v_mov_b32 v250, s5
    v_mov_b32 v251, s5
    s_lshl_b32 s36, s2, 2
    s_add_u32 s36, s36, s4
    s_lshl_b32 s36, s36, 11
    s_add_u32 s36, s36, 0x400000
    s_lshl_b32 s37, s4, 8
    s_add_u32 s37, s37, s2
    s_lshl_b32 s37, s37, 4
    s_add_u32 s37, s37, 0x40000
    s_mov_b32 s3, 0x3f803f80
    s_waitcnt vmcnt(12)
    v_dot2c_f32_bf16 v120, s3, v112
    v_dot2c_f32_bf16 v122, v112, v112
    v_dot2c_f32_bf16 v121, s3, v113
    v_dot2c_f32_bf16 v123, v113, v113
    v_dot2c_f32_bf16 v120, s3, v114
    v_dot2c_f32_bf16 v122, v114, v114
    v_dot2c_f32_bf16 v121, s3, v115
    v_dot2c_f32_bf16 v123, v115, v115
    v_dot2c_f32_bf16 v120, s3, v116
    v_dot2c_f32_bf16 v122, v116, v116
    v_dot2c_f32_bf16 v121, s3, v117
    v_dot2c_f32_bf16 v123, v117, v117
    v_dot2c_f32_bf16 v120, s3, v118
    v_dot2c_f32_bf16 v122, v118, v118
    v_dot2c_f32_bf16 v121, s3, v119
    v_dot2c_f32_bf16 v123, v119, v119
    s_nop 1
    v_add_f32 v120, v120, v121
    v_add_f32 v122, v122, v123
    s_nop 0
    v_add_f32_dpp v120, v120, v120 quad_perm:[1,0,3,2] row_mask:0xf bank_mask:0xf
    v_add_f32_dpp v122, v122, v122 quad_perm:[1,0,3,2] row_mask:0xf bank_mask:0xf
    s_nop 0
    v_add_f32_dpp v120, v120, v120 quad_perm:[2,3,0,1] row_mask:0xf bank_mask:0xf
    v_add_f32_dpp v122, v122, v122 quad_perm:[2,3,0,1] row_mask:0xf bank_mask:0xf
    s_nop 0
    v_add_f32_dpp v120, v120, v120 row_half_mirror row_mask:0xf bank_mask:0xf
    v_add_f32_dpp v122, v122, v122 row_half_mirror row_mask:0xf bank_mask:0xf
    s_nop 0
    v_add_f32_dpp v120, v120, v120 row_mirror row_mask:0xf bank_mask:0xf
    v_add_f32_dpp v122, v122, v122 row_mirror row_mask:0xf bank_mask:0xf
    s_nop 0
    v_add_f32_dpp v120, v120, v120 row_bcast:15 row_mask:0xa bank_mask:0xf
    v_add_f32_dpp v122, v122, v122 row_bcast:15 row_mask:0xa bank_mask:0xf
    v_mul_f32 v120, 0x3b000000, v120
    v_mul_f32 v122, 0x3b000000, v122
    v_fma_f32 v122, -v120, v120, v122
    v_max_f32 v122, 0, v122
    v_cvt_pk_bf16_f32 v122, v122, v122
    v_lshlrev_b32 v122, 16, v122
    v_add_f32 v122, 0x3727c5ac, v122
    v_cvt_pk_bf16_f32 v122, v122, v122
    v_lshlrev_b32 v122, 16, v122
    v_sqrt_f32 v122, v122
    s_nop 0
    v_cvt_pk_bf16_f32 v120, v120, v122
    s_mov_b32 exec_lo, 0x10000
    s_mov_b32 exec_hi, 0x10000
    ds_write_b32 v124, v120
    s_mov_b64 exec, -1
    s_waitcnt vmcnt(4)
    v_xor_b32 v8, v126, v8
    v_xor_b32 v9, v126, v9
    v_xor_b32 v10, v126, v10
    v_xor_b32 v11, v126, v11
    buffer_store_dwordx4 v[8:11], v21, s[40:43], s60 offen offset:0 sc1
    v_xor_b32 v12, v126, v12
    v_xor_b32 v13, v126, v13
    v_xor_b32 v14, v126, v14
    v_xor_b32 v15, v126, v15
    buffer_store_dwordx4 v[12:15], v21, s[40:43], s60 offen offset:128 sc1
    v_add3_u32 v114, v8, v9, v10
    v_add3_u32 v115, v11, v12, v13
    v_add3_u32 v114, v114, v14, v15
    v_add_u32 v114, v114, v115
    s_nop 1
    v_add_u32_dpp v114, v114, v114 quad_perm:[1,0,3,2] row_mask:0xf bank_mask:0xf
    s_nop 1
    v_add_u32_dpp v114, v114, v114 quad_perm:[2,3,0,1] row_mask:0xf bank_mask:0xf
    s_nop 1
    v_add_u32_dpp v114, v114, v114 row_half_mirror row_mask:0xf bank_mask:0xf
    v_xor_b32 v114, s5, v114
    ds_write_b32 v16, v114
    v_mov_b32 v112, 0x27400
    v_mov_b32 v113, 1
    s_mov_b64 exec, 1
    ds_add_u32 v112, v113
    s_mov_b64 exec, -1
    s_cmp_lg_u32 s4, 3
    s_cbranch_scc1 L_nopub
    s_branch L_ev0_t
L_ev0:
    s_add_u32 s0, s0, 1
    s_cmp_gt_u32 s0, 4194304
    s_cbranch_scc1 L_ev0_x
L_ev0_t:
    ds_read_b32 v113, v112
    s_waitcnt lgkmcnt(0)
    v_cmp_gt_u32 vcc, 4, v113
    s_cbranch_vccnz L_ev0
L_ev0_x:
    s_mov_b64 exec, 0xffff
    ds_read_b128 v[112:115], v125
    s_waitcnt lgkmcnt(0)
    s_mov_b64 exec, 0xff
    v_mov_b32 v115, s5
    s_mov_b64 exec, 0xffff
    buffer_store_dwordx4 v[112:115], v17, s[40:43], s53 offen sc1
    s_mov_b64 exec, -1
L_nopub:
    s_waitcnt vmcnt(0)
    s_mov_b32 s6, 0x00003f80
    s_mov_b32 s7, 0x3f800000
    v_mov_b32 v64, 0
    v_mov_b32 v65, 0
    v_mov_b32 v66, 0
    v_mov_b32 v67, 0
    v_mov_b32 v68, 0
    v_mov_b32 v69, 0
    v_mov_b32 v70, 0
    v_mov_b32 v71, 0
    v_dot2c_f32_bf16 v64, s6, v224
    v_dot2c_f32_bf16 v65, s7, v224
    v_dot2c_f32_bf16 v66, s6, v225
    v_dot2c_f32_bf16 v67, s7, v225
    v_dot2c_f32_bf16 v68, s6, v226
    v_dot2c_f32_bf16 v69, s7, v226
    v_dot2c_f32_bf16 v70, s6, v227
    v_dot2c_f32_bf16 v71, s7, v227
    v_dot2c_f32_bf16 v64, s6, v228
    v_dot2c_f32_bf16 v65, s7, v228
    v_dot2c_f32_bf16 v66, s6, v229
    v_dot2c_f32_bf16 v67, s7, v229
    v_dot2c_f32_bf16 v68, s6, v230
    v_dot2c_f32_bf16 v69, s7, v230
    v_dot2c_f32_bf16 v70, s6, v231
    v_dot2c_f32_bf16 v71, s7, v231
    v_dot2c_f32_bf16 v64, s6, v232
    v_dot2c_f32_bf16 v65, s7, v232
    v_dot2c_f32_bf16 v66, s6, v233
    v_dot2c_f32_bf16 v67, s7, v233
    v_dot2c_f32_bf16 v68, s6, v234
    v_dot2c_f32_bf16 v69, s7, v234
    v_dot2c_f32_bf16 v70, s6, v235
    v_dot2c_f32_bf16 v71, s7, v235
    v_dot2c_f32_bf16 v64, s6, v236
    v_dot2c_f32_bf16 v65, s7, v236
    v_dot2c_f32_bf16 v66, s6, v237
    v_dot2c_f32_bf16 v67, s7, v237
    v_dot2c_f32_bf16 v68, s6, v238
    v_dot2c_f32_bf16 v69, s7, v238
    v_dot2c_f32_bf16 v70, s6, v239
    v_dot2c_f32_bf16 v71, s7, v239
    v_add_f32_dpp v64, v64, v64 row_ror:2 row_mask:0xf bank_mask:0xf
    v_add_f32_dpp v65, v65, v65 row_ror:2 row_mask:0xf bank_mask:0xf
    v_add_f32_dpp v66, v66, v66 row_ror:2 row_mask:0xf bank_mask:0xf
    v_add_f32_dpp v67, v67, v67 row_ror:2 row_mask:0xf bank_mask:0xf
    v_add_f32_dpp v68, v68, v68 row_ror:2 row_mask:0xf bank_mask:0xf
    v_add_f32_dpp v69, v69, v69 row_ror:2 row_mask:0xf bank_mask:0xf
    v_add_f32_dpp v70, v70, v70 row_ror:2 row_mask:0xf bank_mask:0xf
    v_add_f32_dpp v71, v71, v71 row_ror:2 row_mask:0xf bank_mask:0xf
    v_add_f32_dpp v64, v64, v64 row_ror:4 row_mask:0xf bank_mask:0xf
    v_add_f32_dpp v65, v65, v65 row_ror:4 row_mask:0xf bank_mask:0xf
    v_add_f32_dpp v66, v66, v66 row_ror:4 row_mask:0xf bank_mask:0xf
    v_add_f32_dpp v67, v67, v67 row_ror:4 row_mask:0xf bank_mask:0xf
    v_add_f32_dpp v68, v68, v68 row_ror:4 row_mask:0xf bank_mask:0xf
    v_add_f32_dpp v69, v69, v69 row_ror:4 row_mask:0xf bank_mask:0xf
    v_add_f32_dpp v70, v70, v70 row_ror:4 row_mask:0xf bank_mask:0xf
    v_add_f32_dpp v71, v71, v71 row_ror:4 row_mask:0xf bank_mask:0xf
    v_add_f32_dpp v64, v64, v64 row_ror:8 row_mask:0xf bank_mask:0xf
    v_add_f32_dpp v65, v65, v65 row_ror:8 row_mask:0xf bank_mask:0xf
    v_add_f32_dpp v66, v66, v66 row_ror:8 row_mask:0xf bank_mask:0xf
    v_add_f32_dpp v67, v67, v67 row_ror:8 row_mask:0xf bank_mask:0xf
    v_add_f32_dpp v68, v68, v68 row_ror:8 row_mask:0xf bank_mask:0xf
    v_add_f32_dpp v69, v69, v69 row_ror:8 row_mask:0xf bank_mask:0xf
    v_add_f32_dpp v70, v70, v70 row_ror:8 row_mask:0xf bank_mask:0xf
    v_add_f32_dpp v71, v71, v71 row_ror:8 row_mask:0xf bank_mask:0xf
    s_lshl_b32 s3, s4, 8
    s_add_u32 s3, s3, 162816
    v_lshrrev_b32 v72, 4, v1
    v_lshl_add_u32 v72, v72, 6, s3
    v_and_b32 v73, 1, v1
    v_lshl_add_u32 v72, v73, 5, v72
    s_mov_b32 exec_lo, 0x00030003
    s_mov_b32 exec_hi, 0x00030003
    ds_write_b128 v72, v[64:67]
    ds_write_b128 v72, v[68:71] offset:16
    s_mov_b64 exec, -1
    v_mov_b32 v112, 0x27478
    s_branch L_cwk_t
L_cwk:
    s_add_u32 s0, s0, 1
    s_cmp_gt_u32 s0, 4194304
    s_cbranch_scc1 L_cwk_x
L_cwk_t:
    ds_read_b32 v113, v112
    s_waitcnt lgkmcnt(0)
    v_cmp_gt_u32 vcc, 4, v113
    s_cbranch_vccnz L_cwk
L_cwk_x:
L_pollx:
    buffer_load_dwordx4 v[24:27], v2, s[40:43], s54 offen offset:0 sc1
    buffer_load_dwordx4 v[28:31], v2, s[40:43], s54 offen offset:128 sc1
    buffer_load_dword v32, v18, s[40:43], s52 offen sc1
    buffer_load_dwordx4 v[64:67], v3, s[40:43], s57 offen offset:0 sc1
    buffer_load_dwordx4 v[68:71], v3, s[40:43], s57 offen offset:2048 sc1
    buffer_load_dwordx4 v[72:75], v3, s[40:43], s58 offen offset:0 sc1
    buffer_load_dwordx4 v[76:79], v3, s[40:43], s58 offen offset:2048 sc1
    s_waitcnt vmcnt(4)
    v_add3_u32 v34, v24, v25, v26
    v_add3_u32 v35, v27, v28, v29
    v_add3_u32 v34, v34, v30, v31
    v_add_u32 v34, v34, v35
    s_nop 1
    v_add_u32_dpp v34, v34, v34 quad_perm:[1,0,3,2] row_mask:0xf bank_mask:0xf
    s_nop 1
    v_add_u32_dpp v34, v34, v34 quad_perm:[2,3,0,1] row_mask:0xf bank_mask:0xf
    s_nop 1
    v_add_u32_dpp v34, v34, v34 row_half_mirror row_mask:0xf bank_mask:0xf
    v_xor_b32 v32, v32, v34
    s_add_u32 s69, s69, 1
    s_waitcnt vmcnt(0)
L_pollx_c:
    v_xor_b32 v32, s5, v32
    v_xor_b32 v67, s5, v67
    v_xor_b32 v71, s5, v71
    v_xor_b32 v75, s5, v75
    v_xor_b32 v79, s5, v79
    v_or3_b32 v32, v32, v67, v71
    v_or3_b32 v32, v32, v75, v79
    v_cmp_ne_u32 vcc, 0, v32
    s_cbranch_vccz L_pollx_done
    s_cmp_lt_u32 s69, 262144
    s_cbranch_scc1 L_pollx
L_pollx_done:
    ds_write_b128 v22, v[64:67] offset:0
    ds_write_b128 v22, v[68:71] offset:1280
    ds_write_b128 v22, v[72:75] offset:2560
    ds_write_b128 v22, v[76:79] offset:3840
    ds_read_b128 v[36:39], v23 offset:0
    ds_read_b128 v[40:43], v23 offset:16
    ds_read_b128 v[44:47], v23 offset:32
    v_xor_b32 v24, v126, v24
    v_lshlrev_b32 v48, 16, v24
    v_and_b32 v56, s59, v24
    v_xor_b32 v25, v126, v25
    v_lshlrev_b32 v49, 16, v25
    v_and_b32 v57, s59, v25
    v_xor_b32 v26, v126, v26
    v_lshlrev_b32 v50, 16, v26
    v_and_b32 v58, s59, v26
    v_xor_b32 v27, v126, v27
    v_lshlrev_b32 v51, 16, v27
    v_and_b32 v59, s59, v27
    v_xor_b32 v28, v126, v28
    v_lshlrev_b32 v52, 16, v28
    v_and_b32 v60, s59, v28
    v_xor_b32 v29, v126, v29
    v_lshlrev_b32 v53, 16, v29
    v_and_b32 v61, s59, v29
    v_xor_b32 v30, v126, v30
    v_lshlrev_b32 v54, 16, v30
    v_and_b32 v62, s59, v30
    v_xor_b32 v31, v126, v31
    v_lshlrev_b32 v55, 16, v31
    v_and_b32 v63, s59, v31
    s_waitcnt lgkmcnt(0)
    v_and_b32 v80, s59, v36
    v_lshlrev_b32 v88, 16, v36
    v_rcp_f32 v80, v80
    v_and_b32 v81, s59, v37
    v_lshlrev_b32 v89, 16, v37
    v_rcp_f32 v81, v81
    v_and_b32 v82, s59, v38
    v_lshlrev_b32 v90, 16, v38
    v_rcp_f32 v82, v82
    v_and_b32 v83, s59, v40
    v_lshlrev_b32 v91, 16, v40
    v_rcp_f32 v83, v83
    v_and_b32 v84, s59, v41
    v_lshlrev_b32 v92, 16, v41
    v_rcp_f32 v84, v84
    v_and_b32 v85, s59, v42
    v_lshlrev_b32 v93, 16, v42
    v_rcp_f32 v85, v85
    v_and_b32 v86, s59, v44
    v_lshlrev_b32 v94, 16, v44
    v_rcp_f32 v86, v86
    v_and_b32 v87, s59, v45
    v_lshlrev_b32 v95, 16, v45
    v_rcp_f32 v87, v87
    v_pk_add_f32 v[64:65], v[48:49], v[88:89] neg_lo:[0,1] neg_hi:[0,1]
    v_pk_add_f32 v[72:73], v[56:57], v[88:89] neg_lo:[0,1] neg_hi:[0,1]
    v_pk_add_f32 v[66:67], v[50:51], v[90:91] neg_lo:[0,1] neg_hi:[0,1]
    v_pk_add_f32 v[74:75], v[58:59], v[90:91] neg_lo:[0,1] neg_hi:[0,1]
    v_pk_add_f32 v[68:69], v[52:53], v[92:93] neg_lo:[0,1] neg_hi:[0,1]
    v_pk_add_f32 v[76:77], v[60:61], v[92:93] neg_lo:[0,1] neg_hi:[0,1]
    v_pk_add_f32 v[70:71], v[54:55], v[94:95] neg_lo:[0,1] neg_hi:[0,1]
    v_pk_add_f32 v[78:79], v[62:63], v[94:95] neg_lo:[0,1] neg_hi:[0,1]
    v_cvt_pk_bf16_f32 v8, v64, v72
    v_cvt_pk_bf16_f32 v9, v65, v73
    v_cvt_pk_bf16_f32 v10, v66, v74
    v_cvt_pk_bf16_f32 v11, v67, v75
    v_cvt_pk_bf16_f32 v12, v68, v76
    v_cvt_pk_bf16_f32 v13, v69, v77
    v_cvt_pk_bf16_f32 v14, v70, v78
    v_cvt_pk_bf16_f32 v15, v71, v79
    v_lshlrev_b32 v64, 16, v8
    v_and_b32 v72, s59, v8
    v_lshlrev_b32 v65, 16, v9
    v_and_b32 v73, s59, v9
    v_lshlrev_b32 v66, 16, v10
    v_and_b32 v74, s59, v10
    v_lshlrev_b32 v67, 16, v11
    v_and_b32 v75, s59, v11
    v_lshlrev_b32 v68, 16, v12
    v_and_b32 v76, s59, v12
    v_lshlrev_b32 v69, 16, v13
    v_and_b32 v77, s59, v13
    v_lshlrev_b32 v70, 16, v14
    v_and_b32 v78, s59, v14
    v_lshlrev_b32 v71, 16, v15
    v_and_b32 v79, s59, v15
    v_pk_mul_f32 v[64:65], v[64:65], v[80:81]
    v_pk_mul_f32 v[72:73], v[72:73], v[80:81]
    v_pk_mul_f32 v[66:67], v[66:67], v[82:83]
    v_pk_mul_f32 v[74:75], v[74:75], v[82:83]
    v_pk_mul_f32 v[68:69], v[68:69], v[84:85]
    v_pk_mul_f32 v[76:77], v[76:77], v[84:85]
    v_pk_mul_f32 v[70:71], v[70:71], v[86:87]
    v_pk_mul_f32 v[78:79], v[78:79], v[86:87]
    v_cvt_pk_bf16_f32 v16, v64, v65
    v_cvt_pk_bf16_f32 v17, v66, v67
    v_cvt_pk_bf16_f32 v18, v68, v69
    v_cvt_pk_bf16_f32 v19, v70, v71
    ds_write_b128 v7, v[16:19] offset:33792
    v_cvt_pk_bf16_f32 v20, v72, v73
    v_cvt_pk_bf16_f32 v21, v74, v75
    v_cvt_pk_bf16_f32 v22, v76, v77
    v_cvt_pk_bf16_f32 v23, v78, v79
    ds_write_b128 v7, v[20:23] offset:38400
    buffer_store_dwordx4 v[244:247], v243, s[40:43], s36 offen offset:0 sc1
    buffer_store_dwordx4 v[244:247], v243, s[40:43], s36 offen offset:1024 sc1
    s_cmp_eq_u32 s64, -1
    s_cbranch_scc1 L_nopool
    buffer_store_dwordx4 v[224:227], v241, s[40:43], s64 offen offset:0 sc1
    buffer_store_dwordx4 v[228:231], v241, s[40:43], s64 offen offset:256 sc1
    buffer_store_dwordx4 v[232:235], v241, s[40:43], s64 offen offset:512 sc1
    buffer_store_dwordx4 v[236:239], v241, s[40:43], s64 offen offset:768 sc1
L_nopool:
    s_lshl_b32 s60, s55, 16
    s_and_b32 s61, s55, s59
    s_waitcnt lgkmcnt(0)
    s_barrier
    ds_read_b128 v[64:67], v5 offset:192
    ds_read_b64_tr_b16 v[96:97], v4 offset:8
    ds_read_b64_tr_b16 v[98:99], v4 offset:0
    ds_read_b128 v[68:71], v5 offset:704
    ds_read_b64_tr_b16 v[100:101], v4 offset:520
    ds_read_b64_tr_b16 v[102:103], v4 offset:512
    ds_read_b128 v[72:75], v5 offset:1216
    ds_read_b64_tr_b16 v[104:105], v4 offset:1032
    ds_read_b64_tr_b16 v[106:107], v4 offset:1024
    ds_read_b128 v[76:79], v5 offset:1728
    ds_read_b64_tr_b16 v[108:109], v4 offset:1544
    ds_read_b64_tr_b16 v[110:111], v4 offset:1536
    s_waitcnt lgkmcnt(9)
    v_mfma_f32_16x16x32_bf16 v[192:195], v[96:99], v[64:67], 0
    ds_read_b128 v[80:83], v5 offset:2240
    ds_read_b64_tr_b16 v[112:113], v4 offset:2056
    s_waitcnt lgkmcnt(10)
    v_mfma_f32_16x16x32_bf16 v[196:199], v[96:99], v[68:71], 0
    ds_read_b64_tr_b16 v[114:115], v4 offset:2048
    ds_read_b128 v[84:87], v5 offset:2752
    s_waitcnt lgkmcnt(10)
    v_mfma_f32_16x16x32_bf16 v[196:199], v[100:103], v[64:67], v[196:199]
    ds_read_b64_tr_b16 v[116:117], v4 offset:2568
    ds_read_b64_tr_b16 v[118:119], v4 offset:2560
    v_mfma_f32_16x16x32_bf16 v[200:203], v[100:103], v[68:71], 0
    ds_read_b128 v[88:91], v5 offset:3264
    ds_read_b64_tr_b16 v[120:121], v4 offset:3080
    s_waitcnt lgkmcnt(13)
    v_mfma_f32_16x16x32_bf16 v[200:203], v[96:99], v[72:75], v[200:203]
    ds_read_b64_tr_b16 v[122:123], v4 offset:3072
    ds_read_b128 v[92:95], v5 offset:3776
    s_waitcnt lgkmcnt(13)
    v_mfma_f32_16x16x32_bf16 v[200:203], v[104:107], v[64:67], v[200:203]
    ds_read_b64_tr_b16 v[124:125], v4 offset:3592
    ds_read_b64_tr_b16 v[126:127], v4 offset:3584
    v_mfma_f32_16x16x32_bf16 v[204:207], v[100:103], v[72:75], 0
    ds_read_b128 v[128:131], v5 offset:128
    v_mfma_f32_16x16x32_bf16 v[204:207], v[104:107], v[68:71], v[204:207]
    ds_read_b64_tr_b16 v[160:161], v4 offset:72
    v_mfma_f32_16x16x32_bf16 v[208:211], v[104:107], v[72:75], 0
    ds_read_b64_tr_b16 v[162:163], v4 offset:64
    s_waitcnt lgkmcnt(15)
    v_mfma_f32_16x16x32_bf16 v[204:207], v[96:99], v[76:79], v[204:207]
    ds_read_b128 v[132:135], v5 offset:640
    v_mfma_f32_16x16x32_bf16 v[204:207], v[108:111], v[64:67], v[204:207]
    ds_read_b64_tr_b16 v[164:165], v4 offset:584
    v_mfma_f32_16x16x32_bf16 v[208:211], v[100:103], v[76:79], v[208:211]
    ds_read_b64_tr_b16 v[166:167], v4 offset:576
    v_mfma_f32_16x16x32_bf16 v[208:211], v[108:111], v[68:71], v[208:211]
    ds_read_b128 v[136:139], v5 offset:1152
    v_mfma_f32_16x16x32_bf16 v[212:215], v[104:107], v[76:79], 0
    ds_read_b64_tr_b16 v[168:169], v4 offset:1096
    v_mfma_f32_16x16x32_bf16 v[212:215], v[108:111], v[72:75], v[212:215]
    ds_read_b64_tr_b16 v[170:171], v4 offset:1088
    v_mfma_f32_16x16x32_bf16 v[216:219], v[108:111], v[76:79], 0
    ds_read_b128 v[140:143], v5 offset:1664
    s_waitcnt lgkmcnt(15)
    v_mfma_f32_16x16x32_bf16 v[208:211], v[96:99], v[80:83], v[208:211]
    ds_read_b64_tr_b16 v[172:173], v4 offset:1608
    v_mfma_f32_16x16x32_bf16 v[208:211], v[112:115], v[64:67], v[208:211]
    ds_read_b64_tr_b16 v[174:175], v4 offset:1600
    v_mfma_f32_16x16x32_bf16 v[212:215], v[100:103], v[80:83], v[212:215]
    ds_read_b128 v[144:147], v5 offset:2176
    v_mfma_f32_16x16x32_bf16 v[212:215], v[112:115], v[68:71], v[212:215]
    ds_read_b64_tr_b16 v[176:177], v4 offset:2120
    v_mfma_f32_16x16x32_bf16 v[216:219], v[104:107], v[80:83], v[216:219]
    ds_read_b64_tr_b16 v[178:179], v4 offset:2112
    v_mfma_f32_16x16x32_bf16 v[216:219], v[112:115], v[72:75], v[216:219]
    ds_read_b128 v[148:151], v5 offset:2688
    v_mfma_f32_16x16x32_bf16 v[220:223], v[108:111], v[80:83], 0
    ds_read_b64_tr_b16 v[180:181], v4 offset:2632
    v_mfma_f32_16x16x32_bf16 v[220:223], v[112:115], v[76:79], v[220:223]
    ds_read_b64_tr_b16 v[182:183], v4 offset:2624
    v_mfma_f32_16x16x32_bf16 v[212:215], v[96:99], v[84:87], v[212:215]
    ds_read_b128 v[152:155], v5 offset:3200
    v_mfma_f32_16x16x32_bf16 v[212:215], v[116:119], v[64:67], v[212:215]
    ds_read_b64_tr_b16 v[184:185], v4 offset:3144
    v_mfma_f32_16x16x32_bf16 v[216:219], v[100:103], v[84:87], v[216:219]
    ds_read_b64_tr_b16 v[186:187], v4 offset:3136
    v_mfma_f32_16x16x32_bf16 v[216:219], v[116:119], v[68:71], v[216:219]
    ds_read_b128 v[156:159], v5 offset:3712
    v_mfma_f32_16x16x32_bf16 v[220:223], v[104:107], v[84:87], v[220:223]
    ds_read_b64_tr_b16 v[188:189], v4 offset:3656
    v_mfma_f32_16x16x32_bf16 v[220:223], v[116:119], v[72:75], v[220:223]
    ds_read_b64_tr_b16 v[190:191], v4 offset:3648
    v_mfma_f32_16x16x32_bf16 v[216:219], v[96:99], v[88:91], v[216:219]
    v_lshlrev_b32 v8, 16, v16
    s_waitcnt lgkmcnt(15)
    v_mfma_f32_16x16x32_bf16 v[216:219], v[120:123], v[64:67], v[216:219]
    v_and_b32 v9, s59, v16
    v_mfma_f32_16x16x32_bf16 v[220:223], v[100:103], v[88:91], v[220:223]
    v_lshlrev_b32 v40, 16, v20
    v_mfma_f32_16x16x32_bf16 v[220:223], v[120:123], v[68:71], v[220:223]
    v_and_b32 v41, s59, v20
    v_mfma_f32_16x16x32_bf16 v[220:223], v[96:99], v[92:95], v[220:223]
    v_lshlrev_b32 v10, 16, v17
    v_mfma_f32_16x16x32_bf16 v[220:223], v[124:127], v[64:67], v[220:223]
    v_and_b32 v11, s59, v17
    v_mfma_f32_16x16x32_bf16 v[192:195], v[160:163], v[128:131], v[192:195]
    ds_read_b128 v[64:67], v5 offset:64
    v_mfma_f32_16x16x32_bf16 v[196:199], v[160:163], v[132:135], v[196:199]
    ds_read_b64_tr_b16 v[96:97], v4 offset:136
    v_mfma_f32_16x16x32_bf16 v[196:199], v[164:167], v[128:131], v[196:199]
    ds_read_b64_tr_b16 v[98:99], v4 offset:128
    v_mfma_f32_16x16x32_bf16 v[200:203], v[164:167], v[132:135], v[200:203]
    ds_read_b128 v[68:71], v5 offset:576
    v_mfma_f32_16x16x32_bf16 v[200:203], v[160:163], v[136:139], v[200:203]
    ds_read_b64_tr_b16 v[100:101], v4 offset:648
    v_mfma_f32_16x16x32_bf16 v[200:203], v[168:171], v[128:131], v[200:203]
    ds_read_b64_tr_b16 v[102:103], v4 offset:640
    v_mfma_f32_16x16x32_bf16 v[204:207], v[164:167], v[136:139], v[204:207]
    ds_read_b128 v[72:75], v5 offset:1088
    v_mfma_f32_16x16x32_bf16 v[204:207], v[168:171], v[132:135], v[204:207]
    ds_read_b64_tr_b16 v[104:105], v4 offset:1160
    v_mfma_f32_16x16x32_bf16 v[208:211], v[168:171], v[136:139], v[208:211]
    ds_read_b64_tr_b16 v[106:107], v4 offset:1152
    s_waitcnt lgkmcnt(15)
    v_mfma_f32_16x16x32_bf16 v[204:207], v[160:163], v[140:143], v[204:207]
    ds_read_b128 v[76:79], v5 offset:1600
    v_mfma_f32_16x16x32_bf16 v[204:207], v[172:175], v[128:131], v[204:207]
    ds_read_b64_tr_b16 v[108:109], v4 offset:1672
    v_mfma_f32_16x16x32_bf16 v[208:211], v[164:167], v[140:143], v[208:211]
    ds_read_b64_tr_b16 v[110:111], v4 offset:1664
    v_mfma_f32_16x16x32_bf16 v[208:211], v[172:175], v[132:135], v[208:211]
    ds_read_b128 v[80:83], v5 offset:2112
    v_mfma_f32_16x16x32_bf16 v[212:215], v[168:171], v[140:143], v[212:215]
    ds_read_b64_tr_b16 v[112:113], v4 offset:2184
    v_mfma_f32_16x16x32_bf16 v[212:215], v[172:175], v[136:139], v[212:215]
    ds_read_b64_tr_b16 v[114:115], v4 offset:2176
    v_mfma_f32_16x16x32_bf16 v[216:219], v[172:175], v[140:143], v[216:219]
    ds_read_b128 v[84:87], v5 offset:2624
    v_mfma_f32_16x16x32_bf16 v[208:211], v[160:163], v[144:147], v[208:211]
    ds_read_b64_tr_b16 v[116:117], v4 offset:2696
    v_mfma_f32_16x16x32_bf16 v[208:211], v[176:179], v[128:131], v[208:211]
    ds_read_b64_tr_b16 v[118:119], v4 offset:2688
    v_mfma_f32_16x16x32_bf16 v[212:215], v[164:167], v[144:147], v[212:215]
    ds_read_b128 v[88:91], v5 offset:3136
    v_mfma_f32_16x16x32_bf16 v[212:215], v[176:179], v[132:135], v[212:215]
    ds_read_b64_tr_b16 v[120:121], v4 offset:3208
    v_mfma_f32_16x16x32_bf16 v[216:219], v[168:171], v[144:147], v[216:219]
    ds_read_b64_tr_b16 v[122:123], v4 offset:3200
    v_mfma_f32_16x16x32_bf16 v[216:219], v[176:179], v[136:139], v[216:219]
    ds_read_b128 v[92:95], v5 offset:3648
    v_mfma_f32_16x16x32_bf16 v[220:223], v[172:175], v[144:147], v[220:223]
    ds_read_b64_tr_b16 v[124:125], v4 offset:3720
    v_mfma_f32_16x16x32_bf16 v[220:223], v[176:179], v[140:143], v[220:223]
    ds_read_b64_tr_b16 v[126:127], v4 offset:3712
    v_mfma_f32_16x16x32_bf16 v[212:215], v[160:163], v[148:151], v[212:215]
    v_lshlrev_b32 v42, 16, v21
    v_mfma_f32_16x16x32_bf16 v[212:215], v[180:183], v[128:131], v[212:215]
    v_and_b32 v43, s59, v21
    v_mfma_f32_16x16x32_bf16 v[216:219], v[164:167], v[148:151], v[216:219]
    v_lshlrev_b32 v12, 16, v18
    v_mfma_f32_16x16x32_bf16 v[216:219], v[180:183], v[132:135], v[216:219]
    v_and_b32 v13, s59, v18
    v_mfma_f32_16x16x32_bf16 v[220:223], v[168:171], v[148:151], v[220:223]
    v_lshlrev_b32 v44, 16, v22
    v_mfma_f32_16x16x32_bf16 v[220:223], v[180:183], v[136:139], v[220:223]
    v_and_b32 v45, s59, v22
    s_waitcnt lgkmcnt(15)
    v_mfma_f32_16x16x32_bf16 v[216:219], v[160:163], v[152:155], v[216:219]
    v_lshlrev_b32 v14, 16, v19
    v_mfma_f32_16x16x32_bf16 v[216:219], v[184:187], v[128:131], v[216:219]
    v_and_b32 v15, s59, v19
    v_mfma_f32_16x16x32_bf16 v[220:223], v[164:167], v[152:155], v[220:223]
    v_lshlrev_b32 v46, 16, v23
    v_mfma_f32_16x16x32_bf16 v[220:223], v[184:187], v[132:135], v[220:223]
    v_and_b32 v47, s59, v23
    v_mfma_f32_16x16x32_bf16 v[220:223], v[160:163], v[156:159], v[220:223]
    v_fma_f32 v48, v8, s60, v48
    v_mfma_f32_16x16x32_bf16 v[220:223], v[188:191], v[128:131], v[220:223]
    v_fma_f32 v56, v40, s61, v56
    v_mfma_f32_16x16x32_bf16 v[192:195], v[96:99], v[64:67], v[192:195]
    ds_read_b128 v[128:131], v5 offset:0
    v_mfma_f32_16x16x32_bf16 v[196:199], v[96:99], v[68:71], v[196:199]
    ds_read_b64_tr_b16 v[160:161], v4 offset:200
    v_mfma_f32_16x16x32_bf16 v[196:199], v[100:103], v[64:67], v[196:199]
    ds_read_b64_tr_b16 v[162:163], v4 offset:192
    v_mfma_f32_16x16x32_bf16 v[200:203], v[100:103], v[68:71], v[200:203]
    ds_read_b128 v[132:135], v5 offset:512
    v_mfma_f32_16x16x32_bf16 v[200:203], v[96:99], v[72:75], v[200:203]
    ds_read_b64_tr_b16 v[164:165], v4 offset:712
    v_mfma_f32_16x16x32_bf16 v[200:203], v[104:107], v[64:67], v[200:203]
    ds_read_b64_tr_b16 v[166:167], v4 offset:704
    v_mfma_f32_16x16x32_bf16 v[204:207], v[100:103], v[72:75], v[204:207]
    ds_read_b128 v[136:139], v5 offset:1024
    v_mfma_f32_16x16x32_bf16 v[204:207], v[104:107], v[68:71], v[204:207]
    s_waitcnt vmcnt(0)
    s_mov_b64 exec, 1
    buffer_store_dwordx4 v[248:251], v243, s[40:43], s37 offen sc1
    s_mov_b64 exec, -1
    ds_read_b64_tr_b16 v[168:169], v4 offset:1224
    v_mfma_f32_16x16x32_bf16 v[208:211], v[104:107], v[72:75], v[208:211]
    ds_read_b64_tr_b16 v[170:171], v4 offset:1216
    s_waitcnt lgkmcnt(15)
    v_mfma_f32_16x16x32_bf16 v[204:207], v[96:99], v[76:79], v[204:207]
    ds_read_b128 v[140:143], v5 offset:1536
    v_mfma_f32_16x16x32_bf16 v[204:207], v[108:111], v[64:67], v[204:207]
    ds_read_b64_tr_b16 v[172:173], v4 offset:1736
    v_mfma_f32_16x16x32_bf16 v[208:211], v[100:103], v[76:79], v[208:211]
    ds_read_b64_tr_b16 v[174:175], v4 offset:1728
    v_mfma_f32_16x16x32_bf16 v[208:211], v[108:111], v[68:71], v[208:211]
    ds_read_b128 v[144:147], v5 offset:2048
    v_mfma_f32_16x16x32_bf16 v[212:215], v[104:107], v[76:79], v[212:215]
    ds_read_b64_tr_b16 v[176:177], v4 offset:2248
    v_mfma_f32_16x16x32_bf16 v[212:215], v[108:111], v[72:75], v[212:215]
    ds_read_b64_tr_b16 v[178:179], v4 offset:2240
    v_mfma_f32_16x16x32_bf16 v[216:219], v[108:111], v[76:79], v[216:219]
    ds_read_b128 v[148:151], v5 offset:2560
    v_mfma_f32_16x16x32_bf16 v[208:211], v[96:99], v[80:83], v[208:211]
    ds_read_b64_tr_b16 v[180:181], v4 offset:2760
    v_mfma_f32_16x16x32_bf16 v[208:211], v[112:115], v[64:67], v[208:211]
    ds_read_b64_tr_b16 v[182:183], v4 offset:2752
    v_mfma_f32_16x16x32_bf16 v[212:215], v[100:103], v[80:83], v[212:215]
    ds_read_b128 v[152:155], v5 offset:3072
    v_mfma_f32_16x16x32_bf16 v[212:215], v[112:115], v[68:71], v[212:215]
    ds_read_b64_tr_b16 v[184:185], v4 offset:3272
    v_mfma_f32_16x16x32_bf16 v[216:219], v[104:107], v[80:83], v[216:219]
    ds_read_b64_tr_b16 v[186:187], v4 offset:3264
    v_mfma_f32_16x16x32_bf16 v[216:219], v[112:115], v[72:75], v[216:219]
    ds_read_b128 v[156:159], v5 offset:3584
    v_mfma_f32_16x16x32_bf16 v[220:223], v[108:111], v[80:83], v[220:223]
    ds_read_b64_tr_b16 v[188:189], v4 offset:3784
    v_mfma_f32_16x16x32_bf16 v[220:223], v[112:115], v[76:79], v[220:223]
    ds_read_b64_tr_b16 v[190:191], v4 offset:3776
    v_mfma_f32_16x16x32_bf16 v[212:215], v[96:99], v[84:87], v[212:215]
    v_fma_f32 v49, v9, s60, v49
    v_mfma_f32_16x16x32_bf16 v[212:215], v[116:119], v[64:67], v[212:215]
    v_fma_f32 v57, v41, s61, v57
    v_mfma_f32_16x16x32_bf16 v[216:219], v[100:103], v[84:87], v[216:219]
    v_fma_f32 v50, v10, s60, v50
    v_mfma_f32_16x16x32_bf16 v[216:219], v[116:119], v[68:71], v[216:219]
    v_fma_f32 v58, v42, s61, v58
    v_mfma_f32_16x16x32_bf16 v[220:223], v[104:107], v[84:87], v[220:223]
    v_fma_f32 v51, v11, s60, v51
    v_mfma_f32_16x16x32_bf16 v[220:223], v[116:119], v[72:75], v[220:223]
    v_fma_f32 v59, v43, s61, v59
    s_waitcnt lgkmcnt(15)
    v_mfma_f32_16x16x32_bf16 v[216:219], v[96:99], v[88:91], v[216:219]
    v_fma_f32 v52, v12, s60, v52
    v_mfma_f32_16x16x32_bf16 v[216:219], v[120:123], v[64:67], v[216:219]
    v_fma_f32 v60, v44, s61, v60
    v_mfma_f32_16x16x32_bf16 v[220:223], v[100:103], v[88:91], v[220:223]
    v_fma_f32 v53, v13, s60, v53
    v_mfma_f32_16x16x32_bf16 v[220:223], v[120:123], v[68:71], v[220:223]
    v_fma_f32 v61, v45, s61, v61
    v_mfma_f32_16x16x32_bf16 v[220:223], v[96:99], v[92:95], v[220:223]
    v_fma_f32 v54, v14, s60, v54
    v_mfma_f32_16x16x32_bf16 v[220:223], v[124:127], v[64:67], v[220:223]
    v_fma_f32 v62, v46, s61, v62
    v_mfma_f32_16x16x32_bf16 v[192:195], v[160:163], v[128:131], v[192:195]
    v_fma_f32 v55, v15, s60, v55
    v_fma_f32 v63, v47, s61, v63
    v_mfma_f32_16x16x32_bf16 v[196:199], v[160:163], v[132:135], v[196:199]
    v_lshrrev_b32 v2, 3, v0
    v_lshlrev_b32 v2, 8, v2
    v_mfma_f32_16x16x32_bf16 v[196:199], v[164:167], v[128:131], v[196:199]
    v_and_b32 v3, 7, v0
    v_lshl_add_u32 v2, v3, 4, v2
    v_mfma_f32_16x16x32_bf16 v[200:203], v[160:163], v[136:139], v[200:203]
    v_lshrrev_b32 v3, 5, v0
    v_lshlrev_b32 v3, 10, v3
    v_mfma_f32_16x16x32_bf16 v[200:203], v[164:167], v[132:135], v[200:203]
    v_bfe_u32 v24, v0, 1, 4
    v_lshl_add_u32 v3, v24, 4, v3
    v_mfma_f32_16x16x32_bf16 v[200:203], v[168:171], v[128:131], v[200:203]
    ds_write_b128 v6, v[192:195] offset:0
    s_waitcnt lgkmcnt(15)
    v_mfma_f32_16x16x32_bf16 v[204:207], v[160:163], v[140:143], v[204:207]
    v_and_b32 v24, 1, v0
    v_lshl_add_u32 v3, v24, 9, v3
    v_mfma_f32_16x16x32_bf16 v[204:207], v[164:167], v[136:139], v[204:207]
    ds_write_b128 v6, v[196:199] offset:1024
    v_mfma_f32_16x16x32_bf16 v[204:207], v[168:171], v[132:135], v[204:207]
    v_add_u32 v3, 0x1c600, v3
    s_waitcnt lgkmcnt(14)
    v_mfma_f32_16x16x32_bf16 v[204:207], v[172:175], v[128:131], v[204:207]
    s_waitcnt lgkmcnt(13)
    v_mfma_f32_16x16x32_bf16 v[208:211], v[160:163], v[144:147], v[208:211]
    ds_write_b128 v6, v[200:203] offset:2048
    v_mfma_f32_16x16x32_bf16 v[208:211], v[164:167], v[140:143], v[208:211]
    v_mfma_f32_16x16x32_bf16 v[208:211], v[168:171], v[136:139], v[208:211]
    v_mfma_f32_16x16x32_bf16 v[208:211], v[172:175], v[132:135], v[208:211]
    s_waitcnt lgkmcnt(12)
    v_mfma_f32_16x16x32_bf16 v[208:211], v[176:179], v[128:131], v[208:211]
    ds_write_b128 v6, v[204:207] offset:3072
    s_waitcnt lgkmcnt(12)
    v_mfma_f32_16x16x32_bf16 v[212:215], v[160:163], v[148:151], v[212:215]
    v_mfma_f32_16x16x32_bf16 v[212:215], v[164:167], v[144:147], v[212:215]
    v_mfma_f32_16x16x32_bf16 v[212:215], v[168:171], v[140:143], v[212:215]
    v_mfma_f32_16x16x32_bf16 v[212:215], v[172:175], v[136:139], v[212:215]
    v_mfma_f32_16x16x32_bf16 v[212:215], v[176:179], v[132:135], v[212:215]
    s_nop 0
    ds_write_b128 v6, v[208:211] offset:4096
    s_waitcnt lgkmcnt(11)
    v_mfma_f32_16x16x32_bf16 v[212:215], v[180:183], v[128:131], v[212:215]
    s_waitcnt lgkmcnt(10)
    v_mfma_f32_16x16x32_bf16 v[216:219], v[160:163], v[152:155], v[216:219]
    v_mfma_f32_16x16x32_bf16 v[216:219], v[164:167], v[148:151], v[216:219]
    v_mfma_f32_16x16x32_bf16 v[216:219], v[168:171], v[144:147], v[216:219]
    v_mfma_f32_16x16x32_bf16 v[216:219], v[172:175], v[140:143], v[216:219]
    v_mfma_f32_16x16x32_bf16 v[216:219], v[176:179], v[136:139], v[216:219]
    s_nop 1
    ds_write_b128 v6, v[212:215] offset:5120
    v_mfma_f32_16x16x32_bf16 v[216:219], v[180:183], v[132:135], v[216:219]
    s_waitcnt lgkmcnt(9)
    v_mfma_f32_16x16x32_bf16 v[216:219], v[184:187], v[128:131], v[216:219]
    s_waitcnt lgkmcnt(8)
    v_mfma_f32_16x16x32_bf16 v[220:223], v[160:163], v[156:159], v[220:223]
    v_mfma_f32_16x16x32_bf16 v[220:223], v[164:167], v[152:155], v[220:223]
    v_mfma_f32_16x16x32_bf16 v[220:223], v[168:171], v[148:151], v[220:223]
    v_mfma_f32_16x16x32_bf16 v[220:223], v[172:175], v[144:147], v[220:223]
    v_mfma_f32_16x16x32_bf16 v[220:223], v[176:179], v[140:143], v[220:223]
    s_nop 1
    ds_write_b128 v6, v[216:219] offset:6144
    v_mfma_f32_16x16x32_bf16 v[220:223], v[180:183], v[136:139], v[220:223]
    v_mfma_f32_16x16x32_bf16 v[220:223], v[184:187], v[132:135], v[220:223]
    s_waitcnt lgkmcnt(7)
    v_mfma_f32_16x16x32_bf16 v[220:223], v[188:191], v[128:131], v[220:223]
    s_nop 7
    ds_write_b128 v6, v[220:223] offset:7168
    v_mov_b32 v24, 0x27408
    v_mov_b32 v25, 1
    s_mov_b64 exec, 1
    ds_add_u32 v24, v25
    s_mov_b64 exec, -1
L_ev2:
    ds_read_b32 v25, v24
    ds_read_b128 v[64:67], v3 offset:0
    ds_read_b128 v[72:75], v3 offset:8192
    ds_read_b128 v[80:83], v3 offset:16384
    ds_read_b128 v[88:91], v3 offset:24576
    ds_read_b128 v[68:71], v3 offset:256
    ds_read_b128 v[76:79], v3 offset:8448
    ds_read_b128 v[84:87], v3 offset:16640
    ds_read_b128 v[92:95], v3 offset:24832
    s_add_u32 s0, s0, 1
    s_waitcnt lgkmcnt(8)
    v_cmp_gt_u32 vcc, 4, v25
    s_cbranch_vccz L_ev2_x
    s_cmp_lt_u32 s0, 4194304
    s_cbranch_scc1 L_ev2
L_ev2_x:
    s_lshl_b32 s56, s2, 13
    s_add_u32 s56, s56, 0x400000
    s_waitcnt lgkmcnt(7)
    v_pk_add_f32 v[48:49], v[48:49], v[64:65]
    v_pk_add_f32 v[50:51], v[50:51], v[66:67]
    s_waitcnt lgkmcnt(6)
    v_pk_add_f32 v[48:49], v[48:49], v[72:73]
    v_pk_add_f32 v[50:51], v[50:51], v[74:75]
    s_waitcnt lgkmcnt(5)
    v_pk_add_f32 v[56:57], v[56:57], v[80:81]
    v_pk_add_f32 v[58:59], v[58:59], v[82:83]
    s_waitcnt lgkmcnt(4)
    v_pk_add_f32 v[56:57], v[56:57], v[88:89]
    v_pk_add_f32 v[58:59], v[58:59], v[90:91]
    v_cvt_pk_bf16_f32 v16, v48, v56
    v_cvt_pk_bf16_f32 v17, v49, v57
    v_cvt_pk_bf16_f32 v18, v50, v58
    v_cvt_pk_bf16_f32 v19, v51, v59
    v_min_u32 v16, -2, v16
    v_min_u32 v17, -2, v17
    v_min_u32 v18, -2, v18
    v_min_u32 v19, -2, v19
    buffer_store_dwordx4 v[16:19], v2, s[40:43], s56 offen offset:0 sc1
    s_waitcnt lgkmcnt(3)
    v_pk_add_f32 v[52:53], v[52:53], v[68:69]
    v_pk_add_f32 v[54:55], v[54:55], v[70:71]
    s_waitcnt lgkmcnt(2)
    v_pk_add_f32 v[52:53], v[52:53], v[76:77]
    v_pk_add_f32 v[54:55], v[54:55], v[78:79]
    s_waitcnt lgkmcnt(1)
    v_pk_add_f32 v[60:61], v[60:61], v[84:85]
    v_pk_add_f32 v[62:63], v[62:63], v[86:87]
    s_waitcnt lgkmcnt(0)
    v_pk_add_f32 v[60:61], v[60:61], v[92:93]
    v_pk_add_f32 v[62:63], v[62:63], v[94:95]
    v_cvt_pk_bf16_f32 v20, v52, v60
    v_cvt_pk_bf16_f32 v21, v53, v61
    v_cvt_pk_bf16_f32 v22, v54, v62
    v_cvt_pk_bf16_f32 v23, v55, v63
    v_min_u32 v20, -2, v20
    v_min_u32 v21, -2, v21
    v_min_u32 v22, -2, v22
    v_min_u32 v23, -2, v23
    buffer_store_dwordx4 v[20:23], v2, s[40:43], s56 offen offset:128 sc1
    s_and_b32 s65, s2, 3
    s_lshl_b32 s65, s65, 2
    s_bfe_u32 s3, s2, 0x20003
    s_add_u32 s65, s65, s3
    s_and_b32 s66, s2, 4
    s_lshl_b32 s66, s66, 1
    s_lshr_b32 s3, s2, 5
    s_add_u32 s66, s66, s3
    v_bfe_u32 v2, v1, 3, 1
    v_bfe_u32 v3, v1, 4, 1
    v_lshl_add_u32 v2, v2, 1, v3
    v_lshrrev_b32 v3, 5, v1
    v_lshl_add_u32 v2, v3, 2, v2
    v_lshlrev_b32 v0, 13, v2
    v_and_b32 v2, 4, v2
    v_and_b32 v3, 7, v1
    v_xor_b32 v3, v3, v2
    v_lshl_add_u32 v0, v3, 4, v0
    s_lshl_b32 s64, s65, 2
    s_add_u32 s64, s64, s4
    s_lshl_b32 s64, s64, 7
    s_add_u32 s64, s64, 0x400000
    s_lshl_b32 s67, s4, 12
    s_add_u32 s67, s67, 77824
    v_lshlrev_b32 v15, 4, v1
    v_bfe_u32 v24, v1, 4, 1
    v_bfe_u32 v25, v1, 2, 2
    v_lshrrev_b32 v31, 5, v1
    v_and_b32 v27, 3, v1
    v_lshlrev_b32 v2, 10, v24
    v_lshl_add_u32 v2, v31, 12, v2
    v_lshl_add_u32 v2, v25, 7, v2
    v_lshl_add_u32 v2, v27, 3, v2
    v_lshrrev_b32 v28, 1, v25
    v_lshl_add_u32 v28, v24, 1, v28
    v_lshl_add_u32 v2, v28, 5, v2
    v_xor_b32 v3, 32, v2
    v_xor_b32 v4, 64, v2
    v_xor_b32 v5, 96, v2
    v_add_u32 v6, 0x10000, v2
    v_add_u32 v7, 0x10000, v3
    v_add_u32 v8, 0x10000, v4
    v_add_u32 v9, 0x10000, v5
    v_and_b32 v14, 15, v1
    v_lshl_add_u32 v10, v14, 2, s67
    v_lshrrev_b32 v28, 4, v1
    v_lshl_add_u32 v10, v28, 9, v10
    v_lshl_add_u32 v10, v24, 6, v10
    v_add_u32 v11, 128, v10
    v_xor_b32 v116, 64, v10
    v_xor_b32 v117, 64, v11
    v_lshlrev_b32 v14, 2, v14
    v_add_u32 v14, 0x27000, v14
    s_lshl_b32 s56, s65, 2
    s_add_u32 s56, s56, s4
    s_mul_i32 s56, s56, 114688
    s_add_u32 s56, s56, 0x600000
    s_mul_i32 s57, s66, 3072
    s_add_u32 s57, s57, s56
    s_add_u32 s57, s57, 65536
    s_lshl_b32 s3, s66, 12
    s_add_u32 s56, s56, s3
    s_mov_b32 s69, 0
    s_waitcnt vmcnt(0)
    v_mov_b32 v16, 0x3f803f80
    v_mov_b32 v17, 0x3f803f80
    v_mov_b32 v18, 0x3f803f80
    v_mov_b32 v19, 0x3f803f80
    s_waitcnt lgkmcnt(0)
    s_barrier
    s_cmp_lg_u32 s4, 0
    s_cbranch_scc1 L_cs_skip
    s_cmp_ge_u32 s2, 224
    s_cbranch_scc1 L_cs_skip
    v_mov_b32 v72, 0x27c00
    v_lshl_add_u32 v72, v1, 2, v72
    ds_read2st64_b32 v[64:65], v72 offset0:0 offset1:1
    ds_read2st64_b32 v[66:67], v72 offset0:2 offset1:3
    v_lshlrev_b32 v73, 3, v1
    s_waitcnt lgkmcnt(0)
    v_add_f32 v64, v64, v65
    v_add_f32 v66, v66, v67
    v_add_f32 v64, v64, v66
    v_mov_b32 v65, s5
    buffer_store_dwordx2 v[64:65], v73, s[40:43], s68 offen sc1
L_cs_skip:
    ds_read_b64_tr_b16 v[24:25], v2 offset:0
    ds_read_b64_tr_b16 v[26:27], v2 offset:512
    ds_read_b64_tr_b16 v[28:29], v3 offset:0
    ds_read_b64_tr_b16 v[30:31], v3 offset:512
    ds_read_b64_tr_b16 v[32:33], v4 offset:0
    ds_read_b64_tr_b16 v[34:35], v4 offset:512
    ds_read_b64_tr_b16 v[36:37], v5 offset:0
    ds_read_b64_tr_b16 v[38:39], v5 offset:512
    ds_read_b64_tr_b16 v[40:41], v2 offset:2048
    ds_read_b64_tr_b16 v[42:43], v2 offset:2560
    s_barrier
    ds_read2st64_b32 v[128:129], v10 offset0:0 offset1:1
    ds_read2st64_b32 v[130:131], v11 offset0:0 offset1:1
    ds_read2st64_b32 v[132:133], v116 offset0:0 offset1:1
    ds_read2st64_b32 v[134:135], v117 offset0:0 offset1:1
    ds_read2st64_b32 v[136:137], v10 offset0:8 offset1:9
    ds_read2st64_b32 v[138:139], v11 offset0:8 offset1:9
    ds_read2st64_b32 v[140:141], v116 offset0:8 offset1:9
    ds_read2st64_b32 v[142:143], v117 offset0:8 offset1:9
    s_waitcnt lgkmcnt(0)
    v_max3_u32 v12, v128, v129, v130
    v_max3_u32 v13, v131, v132, v133
    v_max3_u32 v12, v12, v134, v135
    v_max3_u32 v13, v13, v136, v137
    v_max3_u32 v12, v12, v138, v139
    v_max3_u32 v13, v13, v140, v141
    v_max3_u32 v12, v12, v142, v143
    v_max_u32 v12, v12, v13
    v_cmp_eq_u32 vcc, -1, v12
    s_cbranch_vccnz L_tk0_retry
L_tk0_ok:
    v_mfma_f32_16x16x32_bf16 v[48:51], v[24:27], v[128:131], 0
    ds_read_b64_tr_b16 v[44:45], v3 offset:2048
    v_mfma_f32_16x16x32_bf16 v[52:55], v[24:27], v[132:135], 0
    ds_read_b64_tr_b16 v[46:47], v3 offset:2560
    v_mfma_f32_16x16x32_bf16 v[64:67], v[28:31], v[128:131], 0
    ds_read_b64_tr_b16 v[24:25], v4 offset:2048
    v_mfma_f32_16x16x32_bf16 v[68:71], v[28:31], v[132:135], 0
    ds_read_b64_tr_b16 v[26:27], v4 offset:2560
    v_mfma_f32_16x16x32_bf16 v[80:83], v[32:35], v[128:131], 0
    ds_read_b64_tr_b16 v[28:29], v5 offset:2048
    v_mfma_f32_16x16x32_bf16 v[84:87], v[32:35], v[132:135], 0
    ds_read_b64_tr_b16 v[30:31], v5 offset:2560
    v_mfma_f32_16x16x32_bf16 v[96:99], v[36:39], v[128:131], 0
    ds_read_b64_tr_b16 v[32:33], v2 offset:8192
    v_mfma_f32_16x16x32_bf16 v[100:103], v[36:39], v[132:135], 0
    ds_read_b64_tr_b16 v[34:35], v2 offset:8704
    v_mfma_f32_16x16x32_bf16 v[20:23], v[16:19], v[128:131], 0
    s_barrier
    s_waitcnt lgkmcnt(6)
    v_mfma_f32_16x16x32_bf16 v[56:59], v[40:43], v[128:131], 0
    ds_read_b64_tr_b16 v[36:37], v3 offset:8192
    v_mfma_f32_16x16x32_bf16 v[60:63], v[40:43], v[132:135], 0
    ds_read_b64_tr_b16 v[38:39], v3 offset:8704
    ds_read2st64_b32 v[144:145], v10 offset0:64 offset1:65
    ds_read2st64_b32 v[146:147], v11 offset0:64 offset1:65
    v_mfma_f32_16x16x32_bf16 v[72:75], v[44:47], v[128:131], 0
    ds_read_b64_tr_b16 v[40:41], v4 offset:8192
    v_mfma_f32_16x16x32_bf16 v[76:79], v[44:47], v[132:135], 0
    ds_read_b64_tr_b16 v[42:43], v4 offset:8704
    ds_read2st64_b32 v[148:149], v116 offset0:64 offset1:65
    ds_read2st64_b32 v[150:151], v117 offset0:64 offset1:65
    s_waitcnt lgkmcnt(10)
    v_mfma_f32_16x16x32_bf16 v[88:91], v[24:27], v[128:131], 0
    ds_read_b64_tr_b16 v[44:45], v5 offset:8192
    v_mfma_f32_16x16x32_bf16 v[92:95], v[24:27], v[132:135], 0
    ds_read_b64_tr_b16 v[46:47], v5 offset:8704
    ds_read2st64_b32 v[152:153], v10 offset0:72 offset1:73
    ds_read2st64_b32 v[154:155], v11 offset0:72 offset1:73
    v_mfma_f32_16x16x32_bf16 v[104:107], v[28:31], v[128:131], 0
    ds_read_b64_tr_b16 v[24:25], v2 offset:10240
    v_mfma_f32_16x16x32_bf16 v[108:111], v[28:31], v[132:135], 0
    ds_read_b64_tr_b16 v[26:27], v2 offset:10752
    ds_read2st64_b32 v[156:157], v116 offset0:72 offset1:73
    ds_read2st64_b32 v[158:159], v117 offset0:72 offset1:73
    v_mfma_f32_16x16x32_bf16 v[112:115], v[16:19], v[132:135], 0
    s_waitcnt lgkmcnt(14)
    v_mfma_f32_16x16x32_bf16 v[48:51], v[32:35], v[136:139], v[48:51]
    ds_read_b64_tr_b16 v[28:29], v3 offset:10240
    v_mfma_f32_16x16x32_bf16 v[52:55], v[32:35], v[140:143], v[52:55]
    ds_read_b64_tr_b16 v[30:31], v3 offset:10752
    v_mfma_f32_16x16x32_bf16 v[64:67], v[36:39], v[136:139], v[64:67]
    ds_read_b64_tr_b16 v[32:33], v4 offset:10240
    v_mfma_f32_16x16x32_bf16 v[68:71], v[36:39], v[140:143], v[68:71]
    ds_read_b64_tr_b16 v[34:35], v4 offset:10752
    s_waitcnt lgkmcnt(10)
    v_mfma_f32_16x16x32_bf16 v[80:83], v[40:43], v[136:139], v[80:83]
    ds_read_b64_tr_b16 v[36:37], v5 offset:10240
    v_mfma_f32_16x16x32_bf16 v[84:87], v[40:43], v[140:143], v[84:87]
    ds_read_b64_tr_b16 v[38:39], v5 offset:10752
    v_mfma_f32_16x16x32_bf16 v[96:99], v[44:47], v[136:139], v[96:99]
    ds_read_b64_tr_b16 v[40:41], v2 offset:16384
    v_mfma_f32_16x16x32_bf16 v[100:103], v[44:47], v[140:143], v[100:103]
    ds_read_b64_tr_b16 v[42:43], v2 offset:16896
    v_mfma_f32_16x16x32_bf16 v[20:23], v[16:19], v[136:139], v[20:23]
    s_barrier
    s_waitcnt lgkmcnt(6)
    v_mfma_f32_16x16x32_bf16 v[56:59], v[24:27], v[136:139], v[56:59]
    ds_read_b64_tr_b16 v[44:45], v3 offset:16384
    v_mfma_f32_16x16x32_bf16 v[60:63], v[24:27], v[140:143], v[60:63]
    ds_read_b64_tr_b16 v[46:47], v3 offset:16896
    ds_read2st64_b32 v[160:161], v10 offset0:128 offset1:129
    v_max3_u32 v12, v144, v145, v146
    v_max3_u32 v13, v147, v148, v149
    v_mfma_f32_16x16x32_bf16 v[72:75], v[28:31], v[136:139], v[72:75]
    ds_read_b64_tr_b16 v[24:25], v4 offset:16384
    v_max3_u32 v12, v12, v150, v151
    v_mfma_f32_16x16x32_bf16 v[76:79], v[28:31], v[140:143], v[76:79]
    ds_read_b64_tr_b16 v[26:27], v4 offset:16896
    ds_read2st64_b32 v[162:163], v11 offset0:128 offset1:129
    v_max3_u32 v13, v13, v152, v153
    s_waitcnt lgkmcnt(8)
    v_mfma_f32_16x16x32_bf16 v[88:91], v[32:35], v[136:139], v[88:91]
    ds_read_b64_tr_b16 v[28:29], v5 offset:16384
    v_max3_u32 v12, v12, v154, v155
    v_mfma_f32_16x16x32_bf16 v[92:95], v[32:35], v[140:143], v[92:95]
    ds_read_b64_tr_b16 v[30:31], v5 offset:16896
    ds_read2st64_b32 v[164:165], v116 offset0:128 offset1:129
    v_max3_u32 v13, v13, v156, v157
    v_mfma_f32_16x16x32_bf16 v[104:107], v[36:39], v[136:139], v[104:107]
    ds_read_b64_tr_b16 v[32:33], v2 offset:18432
    v_max3_u32 v12, v12, v158, v159
    v_mfma_f32_16x16x32_bf16 v[108:111], v[36:39], v[140:143], v[108:111]
    ds_read_b64_tr_b16 v[34:35], v2 offset:18944
    ds_read2st64_b32 v[166:167], v117 offset0:128 offset1:129
    v_max_u32 v12, v12, v13
    v_mfma_f32_16x16x32_bf16 v[112:115], v[16:19], v[140:143], v[112:115]
    ds_read2st64_b32 v[168:169], v10 offset0:136 offset1:137
    v_cmp_eq_u32 vcc, -1, v12
    ds_read2st64_b32 v[170:171], v11 offset0:136 offset1:137
    ds_read2st64_b32 v[172:173], v116 offset0:136 offset1:137
    s_cbranch_vccnz L_tk1_retry
L_tk1_ok:
    s_waitcnt lgkmcnt(13)
    v_mfma_f32_16x16x32_bf16 v[48:51], v[40:43], v[144:147], v[48:51]
    ds_read_b64_tr_b16 v[36:37], v3 offset:18432
    v_mfma_f32_16x16x32_bf16 v[52:55], v[40:43], v[148:151], v[52:55]
    ds_read_b64_tr_b16 v[38:39], v3 offset:18944
    ds_read2st64_b32 v[174:175], v117 offset0:136 offset1:137
    v_mfma_f32_16x16x32_bf16 v[64:67], v[44:47], v[144:147], v[64:67]
    ds_read_b64_tr_b16 v[40:41], v4 offset:18432
    v_mfma_f32_16x16x32_bf16 v[68:71], v[44:47], v[148:151], v[68:71]
    ds_read_b64_tr_b16 v[42:43], v4 offset:18944
    s_waitcnt lgkmcnt(12)
    v_mfma_f32_16x16x32_bf16 v[80:83], v[24:27], v[144:147], v[80:83]
    ds_read_b64_tr_b16 v[44:45], v5 offset:18432
    v_mfma_f32_16x16x32_bf16 v[84:87], v[24:27], v[148:151], v[84:87]
    ds_read_b64_tr_b16 v[46:47], v5 offset:18944
    v_mfma_f32_16x16x32_bf16 v[96:99], v[28:31], v[144:147], v[96:99]
    ds_read_b64_tr_b16 v[24:25], v2 offset:24576
    v_mfma_f32_16x16x32_bf16 v[100:103], v[28:31], v[148:151], v[100:103]
    ds_read_b64_tr_b16 v[26:27], v2 offset:25088
    v_mfma_f32_16x16x32_bf16 v[20:23], v[16:19], v[144:147], v[20:23]
    s_barrier
    s_waitcnt lgkmcnt(7)
    v_mfma_f32_16x16x32_bf16 v[56:59], v[32:35], v[144:147], v[56:59]
    ds_read_b64_tr_b16 v[28:29], v3 offset:24576
    v_mfma_f32_16x16x32_bf16 v[60:63], v[32:35], v[148:151], v[60:63]
    ds_read_b64_tr_b16 v[30:31], v3 offset:25088
    ds_read2st64_b32 v[176:177], v10 offset0:192 offset1:193
    v_mfma_f32_16x16x32_bf16 v[72:75], v[36:39], v[144:147], v[72:75]
    ds_read_b64_tr_b16 v[32:33], v4 offset:24576
    v_mfma_f32_16x16x32_bf16 v[76:79], v[36:39], v[148:151], v[76:79]
    ds_read_b64_tr_b16 v[34:35], v4 offset:25088
    ds_read2st64_b32 v[178:179], v11 offset0:192 offset1:193
    s_waitcnt lgkmcnt(8)
    v_mfma_f32_16x16x32_bf16 v[88:91], v[40:43], v[144:147], v[88:91]
    ds_read_b64_tr_b16 v[36:37], v5 offset:24576
    v_mfma_f32_16x16x32_bf16 v[92:95], v[40:43], v[148:151], v[92:95]
    ds_read_b64_tr_b16 v[38:39], v5 offset:25088
    ds_read2st64_b32 v[180:181], v116 offset0:192 offset1:193
    v_max3_u32 v12, v160, v161, v162
    v_max3_u32 v13, v163, v164, v165
    v_mfma_f32_16x16x32_bf16 v[104:107], v[44:47], v[144:147], v[104:107]
    ds_read_b64_tr_b16 v[40:41], v2 offset:26624
    v_max3_u32 v12, v12, v166, v167
    v_mfma_f32_16x16x32_bf16 v[108:111], v[44:47], v[148:151], v[108:111]
    ds_read_b64_tr_b16 v[42:43], v2 offset:27136
    ds_read2st64_b32 v[182:183], v117 offset0:192 offset1:193
    v_max3_u32 v13, v13, v168, v169
    v_mfma_f32_16x16x32_bf16 v[112:115], v[16:19], v[148:151], v[112:115]
    s_waitcnt lgkmcnt(10)
    v_mfma_f32_16x16x32_bf16 v[48:51], v[24:27], v[152:155], v[48:51]
    ds_read_b64_tr_b16 v[44:45], v3 offset:26624
    v_max3_u32 v12, v12, v170, v171
    v_mfma_f32_16x16x32_bf16 v[52:55], v[24:27], v[156:159], v[52:55]
    ds_read_b64_tr_b16 v[46:47], v3 offset:27136
    ds_read2st64_b32 v[184:185], v10 offset0:200 offset1:201
    v_max3_u32 v13, v13, v172, v173
    v_mfma_f32_16x16x32_bf16 v[64:67], v[28:31], v[152:155], v[64:67]
    ds_read_b64_tr_b16 v[24:25], v4 offset:26624
    v_max3_u32 v12, v12, v174, v175
    v_mfma_f32_16x16x32_bf16 v[68:71], v[28:31], v[156:159], v[68:71]
    ds_read_b64_tr_b16 v[26:27], v4 offset:27136
    ds_read2st64_b32 v[186:187], v11 offset0:200 offset1:201
    v_max_u32 v12, v12, v13
    s_waitcnt lgkmcnt(10)
    v_mfma_f32_16x16x32_bf16 v[80:83], v[32:35], v[152:155], v[80:83]
    ds_read_b64_tr_b16 v[28:29], v5 offset:26624
    v_cmp_eq_u32 vcc, -1, v12
    v_mfma_f32_16x16x32_bf16 v[84:87], v[32:35], v[156:159], v[84:87]
    ds_read_b64_tr_b16 v[30:31], v5 offset:27136
    ds_read2st64_b32 v[188:189], v116 offset0:200 offset1:201
    v_mfma_f32_16x16x32_bf16 v[96:99], v[36:39], v[152:155], v[96:99]
    ds_read_b64_tr_b16 v[32:33], v2 offset:32768
    v_mfma_f32_16x16x32_bf16 v[100:103], v[36:39], v[156:159], v[100:103]
    ds_read_b64_tr_b16 v[34:35], v2 offset:33280
    ds_read2st64_b32 v[190:191], v117 offset0:200 offset1:201
    s_cbranch_vccnz L_tk2_retry
L_tk2_ok:
    v_mfma_f32_16x16x32_bf16 v[20:23], v[16:19], v[152:155], v[20:23]
    s_barrier
    s_waitcnt lgkmcnt(10)
    v_mfma_f32_16x16x32_bf16 v[56:59], v[40:43], v[152:155], v[56:59]
    ds_read_b64_tr_b16 v[36:37], v3 offset:32768
    v_mfma_f32_16x16x32_bf16 v[60:63], v[40:43], v[156:159], v[60:63]
    ds_read_b64_tr_b16 v[38:39], v3 offset:33280
    v_add_u32 v10, 65536, v10
    v_mfma_f32_16x16x32_bf16 v[72:75], v[44:47], v[152:155], v[72:75]
    ds_read_b64_tr_b16 v[40:41], v4 offset:32768
    v_mfma_f32_16x16x32_bf16 v[76:79], v[44:47], v[156:159], v[76:79]
    ds_read_b64_tr_b16 v[42:43], v4 offset:33280
    v_add_u32 v11, 65536, v11
    s_waitcnt lgkmcnt(8)
    v_mfma_f32_16x16x32_bf16 v[88:91], v[24:27], v[152:155], v[88:91]
    ds_read_b64_tr_b16 v[44:45], v5 offset:32768
    v_mfma_f32_16x16x32_bf16 v[92:95], v[24:27], v[156:159], v[92:95]
    ds_read_b64_tr_b16 v[46:47], v5 offset:33280
    v_add_u32 v116, 65536, v116
    v_mfma_f32_16x16x32_bf16 v[104:107], v[28:31], v[152:155], v[104:107]
    ds_read_b64_tr_b16 v[24:25], v2 offset:34816
    v_mfma_f32_16x16x32_bf16 v[108:111], v[28:31], v[156:159], v[108:111]
    ds_read_b64_tr_b16 v[26:27], v2 offset:35328
    v_add_u32 v117, 65536, v117
    v_mfma_f32_16x16x32_bf16 v[112:115], v[16:19], v[156:159], v[112:115]
    s_waitcnt lgkmcnt(6)
    v_mfma_f32_16x16x32_bf16 v[48:51], v[32:35], v[160:163], v[48:51]
    ds_read_b64_tr_b16 v[28:29], v3 offset:34816
    v_mfma_f32_16x16x32_bf16 v[52:55], v[32:35], v[164:167], v[52:55]
    ds_read_b64_tr_b16 v[30:31], v3 offset:35328
    ds_read2st64_b32 v[192:193], v10 offset0:0 offset1:1
    v_max3_u32 v12, v176, v177, v178
    v_max3_u32 v13, v179, v180, v181
    v_mfma_f32_16x16x32_bf16 v[64:67], v[36:39], v[160:163], v[64:67]
    ds_read_b64_tr_b16 v[32:33], v4 offset:34816
    v_max3_u32 v12, v12, v182, v183
    v_mfma_f32_16x16x32_bf16 v[68:71], v[36:39], v[164:167], v[68:71]
    ds_read_b64_tr_b16 v[34:35], v4 offset:35328
    ds_read2st64_b32 v[194:195], v11 offset0:0 offset1:1
    v_max3_u32 v13, v13, v184, v185
    s_waitcnt lgkmcnt(8)
    v_mfma_f32_16x16x32_bf16 v[80:83], v[40:43], v[160:163], v[80:83]
    ds_read_b64_tr_b16 v[36:37], v5 offset:34816
    v_max3_u32 v12, v12, v186, v187
    v_mfma_f32_16x16x32_bf16 v[84:87], v[40:43], v[164:167], v[84:87]
    ds_read_b64_tr_b16 v[38:39], v5 offset:35328
    ds_read2st64_b32 v[196:197], v116 offset0:0 offset1:1
    v_max3_u32 v13, v13, v188, v189
    v_mfma_f32_16x16x32_bf16 v[96:99], v[44:47], v[160:163], v[96:99]
    ds_read_b64_tr_b16 v[40:41], v2 offset:40960
    v_max3_u32 v12, v12, v190, v191
    v_mfma_f32_16x16x32_bf16 v[100:103], v[44:47], v[164:167], v[100:103]
    ds_read_b64_tr_b16 v[42:43], v2 offset:41472
    ds_read2st64_b32 v[198:199], v117 offset0:0 offset1:1
    v_max_u32 v12, v12, v13
    v_mfma_f32_16x16x32_bf16 v[20:23], v[16:19], v[160:163], v[20:23]
    s_barrier
    s_waitcnt lgkmcnt(10)
    v_mfma_f32_16x16x32_bf16 v[56:59], v[24:27], v[160:163], v[56:59]
    ds_read_b64_tr_b16 v[44:45], v3 offset:40960
    v_cmp_eq_u32 vcc, -1, v12
    v_mfma_f32_16x16x32_bf16 v[60:63], v[24:27], v[164:167], v[60:63]
    ds_read_b64_tr_b16 v[46:47], v3 offset:41472
    ds_read2st64_b32 v[200:201], v10 offset0:8 offset1:9
    v_mfma_f32_16x16x32_bf16 v[72:75], v[28:31], v[160:163], v[72:75]
    ds_read_b64_tr_b16 v[24:25], v4 offset:40960
    v_mfma_f32_16x16x32_bf16 v[76:79], v[28:31], v[164:167], v[76:79]
    ds_read_b64_tr_b16 v[26:27], v4 offset:41472
    ds_read2st64_b32 v[202:203], v11 offset0:8 offset1:9
    s_cbranch_vccnz L_tk3_retry
L_tk3_ok:
    s_waitcnt lgkmcnt(10)
    v_mfma_f32_16x16x32_bf16 v[88:91], v[32:35], v[160:163], v[88:91]
    ds_read_b64_tr_b16 v[28:29], v5 offset:40960
    v_mfma_f32_16x16x32_bf16 v[92:95], v[32:35], v[164:167], v[92:95]
    ds_read_b64_tr_b16 v[30:31], v5 offset:41472
    ds_read2st64_b32 v[204:205], v116 offset0:8 offset1:9
    v_mfma_f32_16x16x32_bf16 v[104:107], v[36:39], v[160:163], v[104:107]
    ds_read_b64_tr_b16 v[32:33], v2 offset:43008
    v_mfma_f32_16x16x32_bf16 v[108:111], v[36:39], v[164:167], v[108:111]
    ds_read_b64_tr_b16 v[34:35], v2 offset:43520
    ds_read2st64_b32 v[206:207], v117 offset0:8 offset1:9
    v_mfma_f32_16x16x32_bf16 v[112:115], v[16:19], v[164:167], v[112:115]
    s_waitcnt lgkmcnt(10)
    v_mfma_f32_16x16x32_bf16 v[48:51], v[40:43], v[168:171], v[48:51]
    ds_read_b64_tr_b16 v[36:37], v3 offset:43008
    v_mfma_f32_16x16x32_bf16 v[52:55], v[40:43], v[172:175], v[52:55]
    ds_read_b64_tr_b16 v[38:39], v3 offset:43520
    v_add_u32 v10, -65536, v10
    v_mfma_f32_16x16x32_bf16 v[20:23], v[16:19], v[168:171], v[20:23]
    v_mfma_f32_16x16x32_bf16 v[64:67], v[44:47], v[168:171], v[64:67]
    ds_read_b64_tr_b16 v[40:41], v4 offset:43008
    v_mfma_f32_16x16x32_bf16 v[68:71], v[44:47], v[172:175], v[68:71]
    ds_read_b64_tr_b16 v[42:43], v4 offset:43520
    v_add_u32 v11, -65536, v11
    v_mfma_f32_16x16x32_bf16 v[112:115], v[16:19], v[172:175], v[112:115]
    s_waitcnt lgkmcnt(8)
    v_mfma_f32_16x16x32_bf16 v[80:83], v[24:27], v[168:171], v[80:83]
    ds_read_b64_tr_b16 v[44:45], v5 offset:43008
    v_mfma_f32_16x16x32_bf16 v[84:87], v[24:27], v[172:175], v[84:87]
    ds_read_b64_tr_b16 v[46:47], v5 offset:43520
    v_add_u32 v116, -65536, v116
    v_mfma_f32_16x16x32_bf16 v[20:23], v[16:19], v[176:179], v[20:23]
    v_mfma_f32_16x16x32_bf16 v[96:99], v[28:31], v[168:171], v[96:99]
    ds_read_b64_tr_b16 v[24:25], v2 offset:49152
    v_mfma_f32_16x16x32_bf16 v[100:103], v[28:31], v[172:175], v[100:103]
    ds_read_b64_tr_b16 v[26:27], v2 offset:49664
    v_add_u32 v117, -65536, v117
    v_mfma_f32_16x16x32_bf16 v[112:115], v[16:19], v[180:183], v[112:115]
    s_barrier
    s_waitcnt lgkmcnt(6)
    v_mfma_f32_16x16x32_bf16 v[56:59], v[32:35], v[168:171], v[56:59]
    ds_read_b64_tr_b16 v[28:29], v3 offset:49152
    v_mfma_f32_16x16x32_bf16 v[60:63], v[32:35], v[172:175], v[60:63]
    ds_read_b64_tr_b16 v[30:31], v3 offset:49664
    ds_read2st64_b32 v[208:209], v10 offset0:0 offset1:1
    v_max3_u32 v12, v192, v193, v194
    v_max3_u32 v13, v195, v196, v197
    v_mfma_f32_16x16x32_bf16 v[20:23], v[16:19], v[184:187], v[20:23]
    v_mfma_f32_16x16x32_bf16 v[72:75], v[36:39], v[168:171], v[72:75]
    ds_read_b64_tr_b16 v[32:33], v4 offset:49152
    v_max3_u32 v12, v12, v198, v199
    v_mfma_f32_16x16x32_bf16 v[76:79], v[36:39], v[172:175], v[76:79]
    ds_read_b64_tr_b16 v[34:35], v4 offset:49664
    ds_read2st64_b32 v[210:211], v11 offset0:0 offset1:1
    v_max3_u32 v13, v13, v200, v201
    v_mfma_f32_16x16x32_bf16 v[112:115], v[16:19], v[188:191], v[112:115]
    s_waitcnt lgkmcnt(8)
    v_mfma_f32_16x16x32_bf16 v[88:91], v[40:43], v[168:171], v[88:91]
    ds_read_b64_tr_b16 v[36:37], v5 offset:49152
    v_max3_u32 v12, v12, v202, v203
    v_mfma_f32_16x16x32_bf16 v[92:95], v[40:43], v[172:175], v[92:95]
    ds_read_b64_tr_b16 v[38:39], v5 offset:49664
    ds_read2st64_b32 v[212:213], v116 offset0:0 offset1:1
    v_max3_u32 v13, v13, v204, v205
    v_mfma_f32_16x16x32_bf16 v[104:107], v[44:47], v[168:171], v[104:107]
    ds_read_b64_tr_b16 v[40:41], v2 offset:51200
    v_max3_u32 v12, v12, v206, v207
    v_mfma_f32_16x16x32_bf16 v[108:111], v[44:47], v[172:175], v[108:111]
    ds_read_b64_tr_b16 v[42:43], v2 offset:51712
    ds_read2st64_b32 v[214:215], v117 offset0:0 offset1:1
    v_max_u32 v12, v12, v13
    s_waitcnt lgkmcnt(10)
    v_mfma_f32_16x16x32_bf16 v[48:51], v[24:27], v[176:179], v[48:51]
    ds_read_b64_tr_b16 v[44:45], v3 offset:51200
    v_cmp_eq_u32 vcc, -1, v12
    v_mfma_f32_16x16x32_bf16 v[52:55], v[24:27], v[180:183], v[52:55]
    ds_read_b64_tr_b16 v[46:47], v3 offset:51712
    ds_read2st64_b32 v[216:217], v10 offset0:8 offset1:9
    v_mfma_f32_16x16x32_bf16 v[64:67], v[28:31], v[176:179], v[64:67]
    ds_read_b64_tr_b16 v[24:25], v4 offset:51200
    v_mfma_f32_16x16x32_bf16 v[68:71], v[28:31], v[180:183], v[68:71]
    ds_read_b64_tr_b16 v[26:27], v4 offset:51712
    ds_read2st64_b32 v[218:219], v11 offset0:8 offset1:9
    s_cbranch_vccnz L_tk4_retry
L_tk4_ok:
    v_mfma_f32_16x16x32_bf16 v[20:23], v[16:19], v[192:195], v[20:23]
    s_waitcnt lgkmcnt(10)
    v_mfma_f32_16x16x32_bf16 v[80:83], v[32:35], v[176:179], v[80:83]
    ds_read_b64_tr_b16 v[28:29], v5 offset:51200
    v_mfma_f32_16x16x32_bf16 v[84:87], v[32:35], v[180:183], v[84:87]
    ds_read_b64_tr_b16 v[30:31], v5 offset:51712
    ds_read2st64_b32 v[220:221], v116 offset0:8 offset1:9
    v_mfma_f32_16x16x32_bf16 v[112:115], v[16:19], v[196:199], v[112:115]
    v_mfma_f32_16x16x32_bf16 v[96:99], v[36:39], v[176:179], v[96:99]
    ds_read_b64_tr_b16 v[32:33], v2 offset:57344
    v_mfma_f32_16x16x32_bf16 v[100:103], v[36:39], v[180:183], v[100:103]
    ds_read_b64_tr_b16 v[34:35], v2 offset:57856
    ds_read2st64_b32 v[222:223], v117 offset0:8 offset1:9
    v_mfma_f32_16x16x32_bf16 v[20:23], v[16:19], v[200:203], v[20:23]
    s_waitcnt lgkmcnt(10)
    v_mfma_f32_16x16x32_bf16 v[56:59], v[40:43], v[176:179], v[56:59]
    ds_read_b64_tr_b16 v[36:37], v3 offset:57344
    v_mfma_f32_16x16x32_bf16 v[60:63], v[40:43], v[180:183], v[60:63]
    ds_read_b64_tr_b16 v[38:39], v3 offset:57856
    ds_read2st64_b32 v[224:225], v10 offset0:64 offset1:65
    v_mfma_f32_16x16x32_bf16 v[112:115], v[16:19], v[204:207], v[112:115]
    v_mfma_f32_16x16x32_bf16 v[72:75], v[44:47], v[176:179], v[72:75]
    ds_read_b64_tr_b16 v[40:41], v4 offset:57344
    v_mfma_f32_16x16x32_bf16 v[76:79], v[44:47], v[180:183], v[76:79]
    ds_read_b64_tr_b16 v[42:43], v4 offset:57856
    ds_read2st64_b32 v[226:227], v11 offset0:64 offset1:65
    s_waitcnt lgkmcnt(10)
    v_mfma_f32_16x16x32_bf16 v[88:91], v[24:27], v[176:179], v[88:91]
    ds_read_b64_tr_b16 v[44:45], v5 offset:57344
    v_mfma_f32_16x16x32_bf16 v[92:95], v[24:27], v[180:183], v[92:95]
    ds_read_b64_tr_b16 v[46:47], v5 offset:57856
    ds_read2st64_b32 v[228:229], v116 offset0:64 offset1:65
    v_mfma_f32_16x16x32_bf16 v[104:107], v[28:31], v[176:179], v[104:107]
    ds_read_b64_tr_b16 v[24:25], v2 offset:59392
    v_mfma_f32_16x16x32_bf16 v[108:111], v[28:31], v[180:183], v[108:111]
    ds_read_b64_tr_b16 v[26:27], v2 offset:59904
    ds_read2st64_b32 v[230:231], v117 offset0:64 offset1:65
    s_barrier
    s_waitcnt lgkmcnt(10)
    v_mfma_f32_16x16x32_bf16 v[48:51], v[32:35], v[184:187], v[48:51]
    ds_read_b64_tr_b16 v[28:29], v3 offset:59392
    v_mfma_f32_16x16x32_bf16 v[52:55], v[32:35], v[188:191], v[52:55]
    ds_read_b64_tr_b16 v[30:31], v3 offset:59904
    ds_read2st64_b32 v[232:233], v10 offset0:72 offset1:73
    v_max3_u32 v12, v208, v209, v210
    v_max3_u32 v13, v211, v212, v213
    v_mfma_f32_16x16x32_bf16 v[64:67], v[36:39], v[184:187], v[64:67]
    ds_read_b64_tr_b16 v[32:33], v4 offset:59392
    v_max3_u32 v12, v12, v214, v215
    v_mfma_f32_16x16x32_bf16 v[68:71], v[36:39], v[188:191], v[68:71]
    ds_read_b64_tr_b16 v[34:35], v4 offset:59904
    ds_read2st64_b32 v[234:235], v11 offset0:72 offset1:73
    v_max3_u32 v13, v13, v216, v217
    s_waitcnt lgkmcnt(10)
    v_mfma_f32_16x16x32_bf16 v[80:83], v[40:43], v[184:187], v[80:83]
    ds_read_b64_tr_b16 v[36:37], v5 offset:59392
    v_max3_u32 v12, v12, v218, v219
    v_mfma_f32_16x16x32_bf16 v[84:87], v[40:43], v[188:191], v[84:87]
    ds_read_b64_tr_b16 v[38:39], v5 offset:59904
    ds_read2st64_b32 v[236:237], v116 offset0:72 offset1:73
    v_max3_u32 v13, v13, v220, v221
    v_mfma_f32_16x16x32_bf16 v[96:99], v[44:47], v[184:187], v[96:99]
    ds_read_b64_tr_b16 v[40:41], v6 offset:0
    v_max3_u32 v12, v12, v222, v223
    v_mfma_f32_16x16x32_bf16 v[100:103], v[44:47], v[188:191], v[100:103]
    ds_read_b64_tr_b16 v[42:43], v6 offset:512
    ds_read2st64_b32 v[238:239], v117 offset0:72 offset1:73
    v_max_u32 v12, v12, v13
    s_waitcnt lgkmcnt(10)
    v_mfma_f32_16x16x32_bf16 v[56:59], v[24:27], v[184:187], v[56:59]
    ds_read_b64_tr_b16 v[44:45], v7 offset:0
    v_cmp_eq_u32 vcc, -1, v12
    v_mfma_f32_16x16x32_bf16 v[60:63], v[24:27], v[188:191], v[60:63]
    ds_read_b64_tr_b16 v[46:47], v7 offset:512
    ds_read2st64_b32 v[240:241], v10 offset0:128 offset1:129
    v_mfma_f32_16x16x32_bf16 v[72:75], v[28:31], v[184:187], v[72:75]
    ds_read_b64_tr_b16 v[24:25], v8 offset:0
    v_mfma_f32_16x16x32_bf16 v[76:79], v[28:31], v[188:191], v[76:79]
    ds_read_b64_tr_b16 v[26:27], v8 offset:512
    ds_read2st64_b32 v[242:243], v11 offset0:128 offset1:129
    s_cbranch_vccnz L_tk5_retry
L_tk5_ok:
    v_mfma_f32_16x16x32_bf16 v[20:23], v[16:19], v[208:211], v[20:23]
    s_waitcnt lgkmcnt(10)
    v_mfma_f32_16x16x32_bf16 v[88:91], v[32:35], v[184:187], v[88:91]
    ds_read_b64_tr_b16 v[28:29], v9 offset:0
    v_mfma_f32_16x16x32_bf16 v[92:95], v[32:35], v[188:191], v[92:95]
    ds_read_b64_tr_b16 v[30:31], v9 offset:512
    ds_read2st64_b32 v[244:245], v116 offset0:128 offset1:129
    v_mfma_f32_16x16x32_bf16 v[112:115], v[16:19], v[212:215], v[112:115]
    v_mfma_f32_16x16x32_bf16 v[104:107], v[36:39], v[184:187], v[104:107]
    ds_read_b64_tr_b16 v[32:33], v6 offset:2048
    v_mfma_f32_16x16x32_bf16 v[108:111], v[36:39], v[188:191], v[108:111]
    ds_read_b64_tr_b16 v[34:35], v6 offset:2560
    ds_read2st64_b32 v[246:247], v117 offset0:128 offset1:129
    v_mfma_f32_16x16x32_bf16 v[20:23], v[16:19], v[216:219], v[20:23]
    s_waitcnt lgkmcnt(10)
    v_mfma_f32_16x16x32_bf16 v[48:51], v[40:43], v[192:195], v[48:51]
    ds_read_b64_tr_b16 v[36:37], v7 offset:2048
    v_mfma_f32_16x16x32_bf16 v[52:55], v[40:43], v[196:199], v[52:55]
    ds_read_b64_tr_b16 v[38:39], v7 offset:2560
    ds_read2st64_b32 v[248:249], v10 offset0:136 offset1:137
    v_max3_u32 v12, v224, v225, v226
    v_max3_u32 v13, v227, v228, v229
    v_mfma_f32_16x16x32_bf16 v[112:115], v[16:19], v[220:223], v[112:115]
    v_mfma_f32_16x16x32_bf16 v[64:67], v[44:47], v[192:195], v[64:67]
    ds_read_b64_tr_b16 v[40:41], v8 offset:2048
    v_max3_u32 v12, v12, v230, v231
    v_mfma_f32_16x16x32_bf16 v[68:71], v[44:47], v[196:199], v[68:71]
    ds_read_b64_tr_b16 v[42:43], v8 offset:2560
    ds_read2st64_b32 v[250:251], v11 offset0:136 offset1:137
    v_max3_u32 v13, v13, v232, v233
    s_waitcnt lgkmcnt(10)
    v_mfma_f32_16x16x32_bf16 v[80:83], v[24:27], v[192:195], v[80:83]
    ds_read_b64_tr_b16 v[44:45], v9 offset:2048
    v_max3_u32 v12, v12, v234, v235
    v_mfma_f32_16x16x32_bf16 v[84:87], v[24:27], v[196:199], v[84:87]
    ds_read_b64_tr_b16 v[46:47], v9 offset:2560
    ds_read2st64_b32 v[252:253], v116 offset0:136 offset1:137
    v_max3_u32 v13, v13, v236, v237
    v_mfma_f32_16x16x32_bf16 v[96:99], v[28:31], v[192:195], v[96:99]
    ds_read_b64_tr_b16 v[24:25], v2 offset:0
    v_max3_u32 v12, v12, v238, v239
    v_mfma_f32_16x16x32_bf16 v[100:103], v[28:31], v[196:199], v[100:103]
    ds_read_b64_tr_b16 v[26:27], v2 offset:512
    ds_read2st64_b32 v[254:255], v117 offset0:136 offset1:137
    v_max_u32 v12, v12, v13
    s_waitcnt lgkmcnt(10)
    v_mfma_f32_16x16x32_bf16 v[56:59], v[32:35], v[192:195], v[56:59]
    ds_read_b64_tr_b16 v[28:29], v3 offset:0
    v_cmp_eq_u32 vcc, -1, v12
    v_mfma_f32_16x16x32_bf16 v[60:63], v[32:35], v[196:199], v[60:63]
    ds_read_b64_tr_b16 v[30:31], v3 offset:512
    v_mfma_f32_16x16x32_bf16 v[72:75], v[36:39], v[192:195], v[72:75]
    ds_read_b64_tr_b16 v[32:33], v4 offset:0
    v_mfma_f32_16x16x32_bf16 v[76:79], v[36:39], v[196:199], v[76:79]
    ds_read_b64_tr_b16 v[34:35], v4 offset:512
    s_cbranch_vccnz L_tk6_retry
L_tk6_ok:
    v_mfma_f32_16x16x32_bf16 v[20:23], v[16:19], v[224:227], v[20:23]
    s_waitcnt lgkmcnt(8)
    v_mfma_f32_16x16x32_bf16 v[88:91], v[40:43], v[192:195], v[88:91]
    ds_read_b64_tr_b16 v[36:37], v5 offset:0
    v_mfma_f32_16x16x32_bf16 v[92:95], v[40:43], v[196:199], v[92:95]
    ds_read_b64_tr_b16 v[38:39], v5 offset:512
    v_mfma_f32_16x16x32_bf16 v[112:115], v[16:19], v[228:231], v[112:115]
    v_mfma_f32_16x16x32_bf16 v[104:107], v[44:47], v[192:195], v[104:107]
    ds_read_b64_tr_b16 v[40:41], v2 offset:2048
    v_mfma_f32_16x16x32_bf16 v[108:111], v[44:47], v[196:199], v[108:111]
    ds_read_b64_tr_b16 v[42:43], v2 offset:2560
    v_mfma_f32_16x16x32_bf16 v[20:23], v[16:19], v[232:235], v[20:23]
    s_waitcnt lgkmcnt(8)
    v_max3_u32 v12, v240, v241, v242
    v_max3_u32 v13, v243, v244, v245
    v_max3_u32 v12, v12, v246, v247
    v_max3_u32 v13, v13, v248, v249
    v_max3_u32 v12, v12, v250, v251
    v_max3_u32 v13, v13, v252, v253
    v_max3_u32 v12, v12, v254, v255
    v_max_u32 v12, v12, v13
    v_cmp_eq_u32 vcc, -1, v12
    s_cbranch_vccnz L_tk7_retry
L_tk7_ok:
    s_barrier
    s_waitcnt lgkmcnt(6)
    v_mfma_f32_16x16x32_bf16 v[48:51], v[24:27], v[200:203], v[48:51]
    ds_read_b64_tr_b16 v[44:45], v3 offset:2048
    v_lshrrev_b32 v12, 4, v1
    v_mfma_f32_16x16x32_bf16 v[52:55], v[24:27], v[204:207], v[52:55]
    ds_read_b64_tr_b16 v[46:47], v3 offset:2560
    ds_read2_b32 v[10:11], v14 offset0:0 offset1:16
    v_lshlrev_b32 v12, 9, v12
    v_mfma_f32_16x16x32_bf16 v[112:115], v[16:19], v[236:239], v[112:115]
    v_mfma_f32_16x16x32_bf16 v[64:67], v[28:31], v[200:203], v[64:67]
    ds_read_b64_tr_b16 v[24:25], v4 offset:2048
    v_bfe_u32 v13, v1, 4, 1
    v_mfma_f32_16x16x32_bf16 v[68:71], v[28:31], v[204:207], v[68:71]
    ds_read_b64_tr_b16 v[26:27], v4 offset:2560
    v_lshl_add_u32 v12, v13, 7, v12
    v_mfma_f32_16x16x32_bf16 v[20:23], v[16:19], v[240:243], v[20:23]
    s_waitcnt lgkmcnt(7)
    v_mfma_f32_16x16x32_bf16 v[80:83], v[32:35], v[200:203], v[80:83]
    ds_read_b64_tr_b16 v[28:29], v5 offset:2048
    v_and_b32 v13, 15, v1
    v_mfma_f32_16x16x32_bf16 v[84:87], v[32:35], v[204:207], v[84:87]
    ds_read_b64_tr_b16 v[30:31], v5 offset:2560
    v_lshl_add_u32 v12, v13, 3, v12
    v_mfma_f32_16x16x32_bf16 v[112:115], v[16:19], v[244:247], v[112:115]
    v_mfma_f32_16x16x32_bf16 v[96:99], v[36:39], v[200:203], v[96:99]
    ds_read_b64_tr_b16 v[32:33], v2 offset:8192
    v_add_u32 v6, 0x17000, v12
    v_mfma_f32_16x16x32_bf16 v[100:103], v[36:39], v[204:207], v[100:103]
    ds_read_b64_tr_b16 v[34:35], v2 offset:8704
    v_xor_b32 v7, 128, v6
    v_mfma_f32_16x16x32_bf16 v[20:23], v[16:19], v[248:251], v[20:23]
    s_mov_b64 exec, 2
    ds_add_u32 v14, v15 offset:1108
    s_mov_b64 exec, -1
    s_waitcnt lgkmcnt(8)
    v_mfma_f32_16x16x32_bf16 v[56:59], v[40:43], v[200:203], v[56:59]
    ds_read_b64_tr_b16 v[36:37], v3 offset:8192
    v_add_u32 v8, 0xf000, v12
    v_mfma_f32_16x16x32_bf16 v[60:63], v[40:43], v[204:207], v[60:63]
    ds_read_b64_tr_b16 v[38:39], v3 offset:8704
    v_and_b32 v12, 16, v1
    v_mfma_f32_16x16x32_bf16 v[112:115], v[16:19], v[252:255], v[112:115]
    v_mfma_f32_16x16x32_bf16 v[72:75], v[44:47], v[200:203], v[72:75]
    ds_read_b64_tr_b16 v[40:41], v4 offset:8192
    v_cmp_ne_u32 vcc, 0, v12
    v_mfma_f32_16x16x32_bf16 v[76:79], v[44:47], v[204:207], v[76:79]
    ds_read_b64_tr_b16 v[42:43], v4 offset:8704
    v_cmp_gt_u32 s[6:7], 32, v1
    s_waitcnt lgkmcnt(7)
    v_mfma_f32_16x16x32_bf16 v[88:91], v[24:27], v[200:203], v[88:91]
    ds_read_b64_tr_b16 v[44:45], v5 offset:8192
    v_mfma_f32_16x16x32_bf16 v[92:95], v[24:27], v[204:207], v[92:95]
    ds_read_b64_tr_b16 v[46:47], v5 offset:8704
    v_mfma_f32_16x16x32_bf16 v[104:107], v[28:31], v[200:203], v[104:107]
    ds_read_b64_tr_b16 v[24:25], v2 offset:10240
    v_mfma_f32_16x16x32_bf16 v[108:111], v[28:31], v[204:207], v[108:111]
    ds_read_b64_tr_b16 v[26:27], v2 offset:10752
    s_waitcnt lgkmcnt(6)
    v_mfma_f32_16x16x32_bf16 v[48:51], v[32:35], v[208:211], v[48:51]
    ds_read_b64_tr_b16 v[28:29], v3 offset:10240
    v_mov_b32 v17, 0
    v_mfma_f32_16x16x32_bf16 v[52:55], v[32:35], v[212:215], v[52:55]
    ds_read_b64_tr_b16 v[30:31], v3 offset:10752
    v_mov_b32 v18, 0
    v_mfma_f32_16x16x32_bf16 v[64:67], v[36:39], v[208:211], v[64:67]
    ds_read_b64_tr_b16 v[32:33], v4 offset:10240
    v_mov_b32 v19, 0
    v_mfma_f32_16x16x32_bf16 v[68:71], v[36:39], v[212:215], v[68:71]
    ds_read_b64_tr_b16 v[34:35], v4 offset:10752
    v_mul_f32 v21, 0x3b000000, v20
    s_waitcnt lgkmcnt(6)
    v_mfma_f32_16x16x32_bf16 v[80:83], v[40:43], v[208:211], v[80:83]
    ds_read_b64_tr_b16 v[36:37], v5 offset:10240
    v_cvt_pk_bf16_f32 v12, -v21, -v21
    v_mfma_f32_16x16x32_bf16 v[84:87], v[40:43], v[212:215], v[84:87]
    ds_read_b64_tr_b16 v[38:39], v5 offset:10752
    v_and_b32 v13, s59, v12
    v_mfma_f32_16x16x32_bf16 v[96:99], v[44:47], v[208:211], v[96:99]
    ds_read_b64_tr_b16 v[40:41], v2 offset:16384
    v_add_f32 v13, v13, v21
    v_mfma_f32_16x16x32_bf16 v[100:103], v[44:47], v[212:215], v[100:103]
    ds_read_b64_tr_b16 v[42:43], v2 offset:16896
    v_cvt_pk_bf16_f32 v13, -v13, -v13
    s_waitcnt lgkmcnt(6)
    v_mfma_f32_16x16x32_bf16 v[56:59], v[24:27], v[208:211], v[56:59]
    ds_read_b64_tr_b16 v[44:45], v2 offset:18432
    v_cndmask_b32 v12, v12, v13, vcc
    v_mfma_f32_16x16x32_bf16 v[60:63], v[24:27], v[212:215], v[60:63]
    ds_read_b64_tr_b16 v[46:47], v2 offset:18944
    v_cndmask_b32 v20, 0, v12, s[6:7]
    v_mfma_f32_16x16x32_bf16 v[72:75], v[28:31], v[208:211], v[72:75]
    ds_read_b64_tr_b16 v[24:25], v2 offset:24576
    v_mul_f32 v113, 0x3b000000, v112
    v_mfma_f32_16x16x32_bf16 v[76:79], v[28:31], v[212:215], v[76:79]
    ds_read_b64_tr_b16 v[26:27], v2 offset:25088
    v_cvt_pk_bf16_f32 v12, -v113, -v113
    s_waitcnt lgkmcnt(6)
    v_mfma_f32_16x16x32_bf16 v[88:91], v[32:35], v[208:211], v[88:91]
    ds_read_b64_tr_b16 v[28:29], v2 offset:26624
    v_and_b32 v13, s59, v12
    v_mfma_f32_16x16x32_bf16 v[92:95], v[32:35], v[212:215], v[92:95]
    ds_read_b64_tr_b16 v[30:31], v2 offset:27136
    v_add_f32 v13, v13, v113
    v_mfma_f32_16x16x32_bf16 v[104:107], v[36:39], v[208:211], v[104:107]
    ds_read_b64_tr_b16 v[32:33], v2 offset:32768
    v_cvt_pk_bf16_f32 v13, -v13, -v13
    v_mfma_f32_16x16x32_bf16 v[108:111], v[36:39], v[212:215], v[108:111]
    ds_read_b64_tr_b16 v[34:35], v2 offset:33280
    v_cndmask_b32 v12, v12, v13, vcc
    s_waitcnt lgkmcnt(6)
    v_mfma_f32_16x16x32_bf16 v[48:51], v[40:43], v[216:219], v[48:51]
    ds_read_b64_tr_b16 v[36:37], v2 offset:34816
    v_cndmask_b32 v22, 0, v12, s[6:7]
    v_mfma_f32_16x16x32_bf16 v[52:55], v[40:43], v[220:223], v[52:55]
    ds_read_b64_tr_b16 v[38:39], v2 offset:35328
    v_cndmask_b32 v9, v21, v113, vcc
    v_mfma_f32_16x16x32_bf16 v[56:59], v[44:47], v[216:219], v[56:59]
    ds_read_b64_tr_b16 v[40:41], v2 offset:40960
    v_mov_b32 v21, 0
    v_mfma_f32_16x16x32_bf16 v[60:63], v[44:47], v[220:223], v[60:63]
    ds_read_b64_tr_b16 v[42:43], v2 offset:41472
    v_mov_b32 v23, 0
    s_waitcnt lgkmcnt(6)
    v_mfma_f32_16x16x32_bf16 v[48:51], v[24:27], v[224:227], v[48:51]
    ds_read_b64_tr_b16 v[44:45], v2 offset:43008
    v_mfma_f32_16x16x32_bf16 v[52:55], v[24:27], v[228:231], v[52:55]
    ds_read_b64_tr_b16 v[46:47], v2 offset:43520
    ds_read2_b32 v[12:13], v14 offset0:32 offset1:48
    v_mfma_f32_16x16x32_bf16 v[56:59], v[28:31], v[224:227], v[56:59]
    ds_read_b64_tr_b16 v[24:25], v2 offset:49152
    v_mfma_f32_16x16x32_bf16 v[60:63], v[28:31], v[228:231], v[60:63]
    ds_read_b64_tr_b16 v[26:27], v2 offset:49664
    v_mov_b32 v16, v10
    s_waitcnt lgkmcnt(7)
    v_mfma_f32_16x16x32_bf16 v[48:51], v[32:35], v[232:235], v[48:51]
    ds_read_b64_tr_b16 v[28:29], v2 offset:51200
    v_mfma_f32_16x16x32_bf16 v[52:55], v[32:35], v[236:239], v[52:55]
    ds_read_b64_tr_b16 v[30:31], v2 offset:51712
    v_mfma_f32_16x16x32_bf16 v[48:51], v[16:19], v[20:23], v[48:51]
    v_mfma_f32_16x16x32_bf16 v[52:55], v[16:19], v[22:25], v[52:55]
    v_mfma_f32_16x16x32_bf16 v[56:59], v[36:39], v[232:235], v[56:59]
    ds_read_b64_tr_b16 v[32:33], v3 offset:16384
    s_andn2_b32 s62, 3, s5
    v_mfma_f32_16x16x32_bf16 v[60:63], v[36:39], v[236:239], v[60:63]
    ds_read_b64_tr_b16 v[34:35], v3 offset:16896
    v_mov_b32 v16, v11
    s_lshl_b32 s62, s62, 2
    s_waitcnt lgkmcnt(7)
    v_mfma_f32_16x16x32_bf16 v[48:51], v[40:43], v[240:243], v[48:51]
    ds_read_b64_tr_b16 v[36:37], v3 offset:18432
    s_and_b32 s3, s5, 0xf3
    v_mfma_f32_16x16x32_bf16 v[52:55], v[40:43], v[244:247], v[52:55]
    ds_read_b64_tr_b16 v[38:39], v3 offset:18944
    v_mfma_f32_16x16x32_bf16 v[56:59], v[16:19], v[20:23], v[56:59]
    v_mfma_f32_16x16x32_bf16 v[60:63], v[16:19], v[22:25], v[60:63]
    s_or_b32 s62, s62, s3
    v_mfma_f32_16x16x32_bf16 v[56:59], v[44:47], v[240:243], v[56:59]
    ds_read_b64_tr_b16 v[40:41], v3 offset:24576
    v_and_b32 v0, 3, v1
    v_mfma_f32_16x16x32_bf16 v[60:63], v[44:47], v[244:247], v[60:63]
    ds_read_b64_tr_b16 v[42:43], v3 offset:25088
    ds_read2_b32 v[10:11], v14 offset0:64 offset1:80
    v_lshlrev_b32 v0, 1, v0
    s_waitcnt lgkmcnt(7)
    v_mfma_f32_16x16x32_bf16 v[48:51], v[24:27], v[248:251], v[48:51]
    ds_read_b64_tr_b16 v[44:45], v3 offset:26624
    v_lshrrev_b32 v2, v0, s62
    v_mfma_f32_16x16x32_bf16 v[52:55], v[24:27], v[252:255], v[52:55]
    ds_read_b64_tr_b16 v[46:47], v3 offset:27136
    v_mov_b32 v16, v12
    v_lshl_or_b32 v2, v2, 15, v2
    v_mfma_f32_16x16x32_bf16 v[56:59], v[28:31], v[248:251], v[56:59]
    ds_read_b64_tr_b16 v[24:25], v3 offset:32768
    s_mov_b32 s62, 0x00010001
    v_mfma_f32_16x16x32_bf16 v[60:63], v[28:31], v[252:255], v[60:63]
    ds_read_b64_tr_b16 v[26:27], v3 offset:33280
    v_mfma_f32_16x16x32_bf16 v[64:67], v[16:19], v[20:23], v[64:67]
    v_mfma_f32_16x16x32_bf16 v[68:71], v[16:19], v[22:25], v[68:71]
    v_and_b32 v2, s62, v2
    s_waitcnt lgkmcnt(7)
    v_mfma_f32_16x16x32_bf16 v[64:67], v[32:35], v[216:219], v[64:67]
    ds_read_b64_tr_b16 v[28:29], v3 offset:34816
    s_mov_b32 s60, 0x10000
    v_mfma_f32_16x16x32_bf16 v[68:71], v[32:35], v[220:223], v[68:71]
    ds_read_b64_tr_b16 v[30:31], v3 offset:35328
    v_mov_b32 v16, v13
    s_mov_b32 s61, 0x07060302
    v_mfma_f32_16x16x32_bf16 v[72:75], v[36:39], v[216:219], v[72:75]
    ds_read_b64_tr_b16 v[32:33], v3 offset:40960
    v_mfma_f32_16x16x32_bf16 v[76:79], v[36:39], v[220:223], v[76:79]
    ds_read_b64_tr_b16 v[34:35], v3 offset:41472
    v_mfma_f32_16x16x32_bf16 v[72:75], v[16:19], v[20:23], v[72:75]
    v_mfma_f32_16x16x32_bf16 v[76:79], v[16:19], v[22:25], v[76:79]
    s_waitcnt lgkmcnt(6)
    v_mfma_f32_16x16x32_bf16 v[64:67], v[40:43], v[224:227], v[64:67]
    ds_read_b64_tr_b16 v[36:37], v3 offset:43008
    v_mfma_f32_16x16x32_bf16 v[68:71], v[40:43], v[228:231], v[68:71]
    ds_read_b64_tr_b16 v[38:39], v3 offset:43520
    ds_read2_b32 v[12:13], v14 offset0:96 offset1:112
    v_mfma_f32_16x16x32_bf16 v[72:75], v[44:47], v[224:227], v[72:75]
    ds_read_b64_tr_b16 v[40:41], v3 offset:49152
    v_mul_f32 v48, v48, v56
    v_mfma_f32_16x16x32_bf16 v[76:79], v[44:47], v[228:231], v[76:79]
    ds_read_b64_tr_b16 v[42:43], v3 offset:49664
    v_mov_b32 v16, v10
    v_mul_f32 v49, v49, v57
    s_waitcnt lgkmcnt(7)
    v_mfma_f32_16x16x32_bf16 v[64:67], v[24:27], v[232:235], v[64:67]
    ds_read_b64_tr_b16 v[44:45], v3 offset:51200
    v_mul_f32 v50, v50, v58
    v_mfma_f32_16x16x32_bf16 v[68:71], v[24:27], v[236:239], v[68:71]
    ds_read_b64_tr_b16 v[46:47], v3 offset:51712
    v_mfma_f32_16x16x32_bf16 v[80:83], v[16:19], v[20:23], v[80:83]
    v_mfma_f32_16x16x32_bf16 v[84:87], v[16:19], v[22:25], v[84:87]
    v_mul_f32 v51, v51, v59
    v_mfma_f32_16x16x32_bf16 v[72:75], v[28:31], v[232:235], v[72:75]
    ds_read_b64_tr_b16 v[24:25], v4 offset:16384
    v_mul_f32 v52, v52, v60
    v_mfma_f32_16x16x32_bf16 v[76:79], v[28:31], v[236:239], v[76:79]
    ds_read_b64_tr_b16 v[26:27], v4 offset:16896
    v_mov_b32 v16, v11
    v_mul_f32 v53, v53, v61
    s_waitcnt lgkmcnt(7)
    v_mfma_f32_16x16x32_bf16 v[64:67], v[32:35], v[240:243], v[64:67]
    ds_read_b64_tr_b16 v[28:29], v4 offset:18432
    v_mul_f32 v54, v54, v62
    v_mfma_f32_16x16x32_bf16 v[68:71], v[32:35], v[244:247], v[68:71]
    ds_read_b64_tr_b16 v[30:31], v4 offset:18944
    v_mfma_f32_16x16x32_bf16 v[88:91], v[16:19], v[20:23], v[88:91]
    v_mfma_f32_16x16x32_bf16 v[92:95], v[16:19], v[22:25], v[92:95]
    v_mul_f32 v55, v55, v63
    v_mfma_f32_16x16x32_bf16 v[72:75], v[36:39], v[240:243], v[72:75]
    ds_read_b64_tr_b16 v[32:33], v4 offset:24576
    v_add_u32 v48, s60, v48
    v_mfma_f32_16x16x32_bf16 v[76:79], v[36:39], v[244:247], v[76:79]
    ds_read_b64_tr_b16 v[34:35], v4 offset:25088
    v_add_u32 v49, s60, v49
    s_waitcnt lgkmcnt(6)
    v_mfma_f32_16x16x32_bf16 v[64:67], v[40:43], v[248:251], v[64:67]
    ds_read_b64_tr_b16 v[36:37], v4 offset:26624
    v_add_u32 v50, s60, v50
    v_mfma_f32_16x16x32_bf16 v[68:71], v[40:43], v[252:255], v[68:71]
    ds_read_b64_tr_b16 v[38:39], v4 offset:27136
    v_mov_b32 v16, v12
    v_add_u32 v51, s60, v51
    v_mfma_f32_16x16x32_bf16 v[72:75], v[44:47], v[248:251], v[72:75]
    ds_read_b64_tr_b16 v[40:41], v4 offset:32768
    v_add_u32 v52, s60, v52
    v_mfma_f32_16x16x32_bf16 v[76:79], v[44:47], v[252:255], v[76:79]
    ds_read_b64_tr_b16 v[42:43], v4 offset:33280
    v_mfma_f32_16x16x32_bf16 v[96:99], v[16:19], v[20:23], v[96:99]
    v_mfma_f32_16x16x32_bf16 v[100:103], v[16:19], v[22:25], v[100:103]
    v_add_u32 v53, s60, v53
    s_waitcnt lgkmcnt(6)
    v_mfma_f32_16x16x32_bf16 v[80:83], v[24:27], v[216:219], v[80:83]
    ds_read_b64_tr_b16 v[44:45], v4 offset:34816
    v_add_u32 v54, s60, v54
    v_mfma_f32_16x16x32_bf16 v[84:87], v[24:27], v[220:223], v[84:87]
    ds_read_b64_tr_b16 v[46:47], v4 offset:35328
    v_mov_b32 v16, v13
    v_add_u32 v55, s60, v55
    v_mfma_f32_16x16x32_bf16 v[88:91], v[28:31], v[216:219], v[88:91]
    ds_read_b64_tr_b16 v[24:25], v4 offset:40960
    v_perm_b32 v56, v49, v48, s61
    v_mfma_f32_16x16x32_bf16 v[92:95], v[28:31], v[220:223], v[92:95]
    ds_read_b64_tr_b16 v[26:27], v4 offset:41472
    v_mfma_f32_16x16x32_bf16 v[104:107], v[16:19], v[20:23], v[104:107]
    v_mfma_f32_16x16x32_bf16 v[108:111], v[16:19], v[22:25], v[108:111]
    v_perm_b32 v57, v51, v50, s61
    s_waitcnt lgkmcnt(6)
    v_mfma_f32_16x16x32_bf16 v[80:83], v[32:35], v[224:227], v[80:83]
    ds_read_b64_tr_b16 v[28:29], v4 offset:43008
    v_perm_b32 v58, v53, v52, s61
    v_mfma_f32_16x16x32_bf16 v[84:87], v[32:35], v[228:231], v[84:87]
    ds_read_b64_tr_b16 v[30:31], v4 offset:43520
    v_perm_b32 v59, v55, v54, s61
    v_mfma_f32_16x16x32_bf16 v[88:91], v[36:39], v[224:227], v[88:91]
    ds_read_b64_tr_b16 v[32:33], v4 offset:49152
    v_permlane16_swap_b32 v56, v58
    v_mfma_f32_16x16x32_bf16 v[92:95], v[36:39], v[228:231], v[92:95]
    ds_read_b64_tr_b16 v[34:35], v4 offset:49664
    v_permlane16_swap_b32 v57, v59
    s_waitcnt lgkmcnt(6)
    v_mfma_f32_16x16x32_bf16 v[80:83], v[40:43], v[232:235], v[80:83]
    ds_read_b64_tr_b16 v[36:37], v4 offset:51200
    v_bfi_b32 v56, s62, v2, v56
    v_mfma_f32_16x16x32_bf16 v[84:87], v[40:43], v[236:239], v[84:87]
    ds_read_b64_tr_b16 v[38:39], v4 offset:51712
    v_bfi_b32 v57, s62, v2, v57
    v_mfma_f32_16x16x32_bf16 v[88:91], v[44:47], v[232:235], v[88:91]
    ds_read_b64_tr_b16 v[40:41], v5 offset:16384
    v_bfi_b32 v58, s62, v2, v58
    v_mfma_f32_16x16x32_bf16 v[92:95], v[44:47], v[236:239], v[92:95]
    ds_read_b64_tr_b16 v[42:43], v5 offset:16896
    v_bfi_b32 v59, s62, v2, v59
    s_waitcnt lgkmcnt(6)
    v_mfma_f32_16x16x32_bf16 v[80:83], v[24:27], v[240:243], v[80:83]
    ds_read_b64_tr_b16 v[44:45], v5 offset:18432
    buffer_store_dwordx4 v[56:59], v15, s[40:43], s56 offen offset:0 sc1
    v_mfma_f32_16x16x32_bf16 v[84:87], v[24:27], v[244:247], v[84:87]
    ds_read_b64_tr_b16 v[46:47], v5 offset:18944
    v_mfma_f32_16x16x32_bf16 v[88:91], v[28:31], v[240:243], v[88:91]
    ds_read_b64_tr_b16 v[24:25], v5 offset:24576
    v_mfma_f32_16x16x32_bf16 v[92:95], v[28:31], v[244:247], v[92:95]
    ds_read_b64_tr_b16 v[26:27], v5 offset:25088
    s_waitcnt lgkmcnt(6)
    v_mfma_f32_16x16x32_bf16 v[80:83], v[32:35], v[248:251], v[80:83]
    ds_read_b64_tr_b16 v[28:29], v5 offset:26624
    v_mul_f32 v64, v64, v72
    v_mfma_f32_16x16x32_bf16 v[84:87], v[32:35], v[252:255], v[84:87]
    ds_read_b64_tr_b16 v[30:31], v5 offset:27136
    v_mul_f32 v65, v65, v73
    v_mfma_f32_16x16x32_bf16 v[88:91], v[36:39], v[248:251], v[88:91]
    ds_read_b64_tr_b16 v[32:33], v5 offset:32768
    v_mul_f32 v66, v66, v74
    v_mfma_f32_16x16x32_bf16 v[92:95], v[36:39], v[252:255], v[92:95]
    ds_read_b64_tr_b16 v[34:35], v5 offset:33280
    v_mul_f32 v67, v67, v75
    s_waitcnt lgkmcnt(6)
    v_mfma_f32_16x16x32_bf16 v[96:99], v[40:43], v[216:219], v[96:99]
    ds_read_b64_tr_b16 v[36:37], v5 offset:34816
    v_mul_f32 v68, v68, v76
    v_mfma_f32_16x16x32_bf16 v[100:103], v[40:43], v[220:223], v[100:103]
    ds_read_b64_tr_b16 v[38:39], v5 offset:35328
    v_mul_f32 v69, v69, v77
    v_mfma_f32_16x16x32_bf16 v[104:107], v[44:47], v[216:219], v[104:107]
    ds_read_b64_tr_b16 v[40:41], v5 offset:40960
    v_mul_f32 v70, v70, v78
    v_mfma_f32_16x16x32_bf16 v[108:111], v[44:47], v[220:223], v[108:111]
    ds_read_b64_tr_b16 v[42:43], v5 offset:41472
    v_mul_f32 v71, v71, v79
    s_waitcnt lgkmcnt(6)
    v_mfma_f32_16x16x32_bf16 v[96:99], v[24:27], v[224:227], v[96:99]
    ds_read_b64_tr_b16 v[44:45], v5 offset:43008
    v_add_u32 v64, s60, v64
    v_mfma_f32_16x16x32_bf16 v[100:103], v[24:27], v[228:231], v[100:103]
    ds_read_b64_tr_b16 v[46:47], v5 offset:43520
    v_add_u32 v65, s60, v65
    v_mfma_f32_16x16x32_bf16 v[104:107], v[28:31], v[224:227], v[104:107]
    ds_read_b64_tr_b16 v[24:25], v5 offset:49152
    v_add_u32 v66, s60, v66
    v_mfma_f32_16x16x32_bf16 v[108:111], v[28:31], v[228:231], v[108:111]
    ds_read_b64_tr_b16 v[26:27], v5 offset:49664
    v_add_u32 v67, s60, v67
    s_waitcnt lgkmcnt(6)
    v_mfma_f32_16x16x32_bf16 v[96:99], v[32:35], v[232:235], v[96:99]
    ds_read_b64_tr_b16 v[28:29], v5 offset:51200
    v_add_u32 v68, s60, v68
    v_mfma_f32_16x16x32_bf16 v[100:103], v[32:35], v[236:239], v[100:103]
    ds_read_b64_tr_b16 v[30:31], v5 offset:51712
    v_add_u32 v69, s60, v69
    s_barrier
    v_mfma_f32_16x16x32_bf16 v[104:107], v[36:39], v[232:235], v[104:107]
    ds_read_b64_tr_b16 v[32:33], v6 offset:0
    v_add_u32 v70, s60, v70
    v_mfma_f32_16x16x32_bf16 v[108:111], v[36:39], v[236:239], v[108:111]
    ds_read_b64_tr_b16 v[34:35], v6 offset:256
    v_add_u32 v71, s60, v71
    s_waitcnt lgkmcnt(6)
    v_mfma_f32_16x16x32_bf16 v[96:99], v[40:43], v[240:243], v[96:99]
    ds_read_b64_tr_b16 v[36:37], v7 offset:0
    v_perm_b32 v72, v65, v64, s61
    v_mfma_f32_16x16x32_bf16 v[100:103], v[40:43], v[244:247], v[100:103]
    ds_read_b64_tr_b16 v[38:39], v7 offset:256
    v_perm_b32 v73, v67, v66, s61
    v_mfma_f32_16x16x32_bf16 v[104:107], v[44:47], v[240:243], v[104:107]
    ds_read_b64_tr_b16 v[40:41], v6 offset:2048
    v_perm_b32 v74, v69, v68, s61
    v_mfma_f32_16x16x32_bf16 v[108:111], v[44:47], v[244:247], v[108:111]
    ds_read_b64_tr_b16 v[42:43], v6 offset:2304
    v_perm_b32 v75, v71, v70, s61
    s_waitcnt lgkmcnt(6)
    v_mfma_f32_16x16x32_bf16 v[96:99], v[24:27], v[248:251], v[96:99]
    ds_read_b64_tr_b16 v[44:45], v7 offset:2048
    v_permlane16_swap_b32 v72, v74
    v_mfma_f32_16x16x32_bf16 v[100:103], v[24:27], v[252:255], v[100:103]
    ds_read_b64_tr_b16 v[46:47], v7 offset:2304
    v_permlane16_swap_b32 v73, v75
    v_mfma_f32_16x16x32_bf16 v[104:107], v[28:31], v[248:251], v[104:107]
    ds_read_b64_tr_b16 v[24:25], v6 offset:4096
    v_bfi_b32 v72, s62, v2, v72
    v_mfma_f32_16x16x32_bf16 v[108:111], v[28:31], v[252:255], v[108:111]
    ds_read_b64_tr_b16 v[26:27], v6 offset:4352
    v_bfi_b32 v73, s62, v2, v73
    s_waitcnt lgkmcnt(6)
    v_mfma_f32_16x16x32_bf16 v[112:115], v[32:35], v[128:131], 0
    ds_read_b64_tr_b16 v[28:29], v7 offset:4096
    v_bfi_b32 v74, s62, v2, v74
    v_mfma_f32_16x16x32_bf16 v[116:119], v[32:35], v[132:135], 0
    ds_read_b64_tr_b16 v[30:31], v7 offset:4352
    v_bfi_b32 v75, s62, v2, v75
    v_mfma_f32_16x16x32_bf16 v[120:123], v[36:39], v[128:131], 0
    ds_read_b64_tr_b16 v[32:33], v6 offset:6144
    buffer_store_dwordx4 v[72:75], v15, s[40:43], s56 offen offset:1024 sc1
    v_mfma_f32_16x16x32_bf16 v[124:127], v[36:39], v[132:135], 0
    ds_read_b64_tr_b16 v[34:35], v6 offset:6400
    s_waitcnt lgkmcnt(6)
    v_mfma_f32_16x16x32_bf16 v[112:115], v[40:43], v[136:139], v[112:115]
    ds_read_b64_tr_b16 v[36:37], v7 offset:6144
    v_mfma_f32_16x16x32_bf16 v[116:119], v[40:43], v[140:143], v[116:119]
    ds_read_b64_tr_b16 v[38:39], v7 offset:6400
    v_mfma_f32_16x16x32_bf16 v[120:123], v[44:47], v[136:139], v[120:123]
    ds_read_b64_tr_b16 v[40:41], v6 offset:8192
    v_mul_f32 v80, v80, v88
    v_mfma_f32_16x16x32_bf16 v[124:127], v[44:47], v[140:143], v[124:127]
    ds_read_b64_tr_b16 v[42:43], v6 offset:8448
    v_mul_f32 v81, v81, v89
    s_waitcnt lgkmcnt(6)
    v_mfma_f32_16x16x32_bf16 v[112:115], v[24:27], v[144:147], v[112:115]
    ds_read_b64_tr_b16 v[44:45], v7 offset:8192
    v_mul_f32 v82, v82, v90
    v_mfma_f32_16x16x32_bf16 v[116:119], v[24:27], v[148:151], v[116:119]
    ds_read_b64_tr_b16 v[46:47], v7 offset:8448
    v_mul_f32 v83, v83, v91
    v_mfma_f32_16x16x32_bf16 v[120:123], v[28:31], v[144:147], v[120:123]
    ds_read_b64_tr_b16 v[24:25], v6 offset:10240
    v_mul_f32 v84, v84, v92
    v_mfma_f32_16x16x32_bf16 v[124:127], v[28:31], v[148:151], v[124:127]
    ds_read_b64_tr_b16 v[26:27], v6 offset:10496
    v_mul_f32 v85, v85, v93
    s_waitcnt lgkmcnt(6)
    v_mfma_f32_16x16x32_bf16 v[112:115], v[32:35], v[152:155], v[112:115]
    ds_read_b64_tr_b16 v[28:29], v7 offset:10240
    v_mul_f32 v86, v86, v94
    v_mfma_f32_16x16x32_bf16 v[116:119], v[32:35], v[156:159], v[116:119]
    ds_read_b64_tr_b16 v[30:31], v7 offset:10496
    v_mul_f32 v87, v87, v95
    v_mfma_f32_16x16x32_bf16 v[120:123], v[36:39], v[152:155], v[120:123]
    ds_read_b64_tr_b16 v[32:33], v6 offset:12288
    v_add_u32 v80, s60, v80
    v_mfma_f32_16x16x32_bf16 v[124:127], v[36:39], v[156:159], v[124:127]
    ds_read_b64_tr_b16 v[34:35], v6 offset:12544
    v_add_u32 v81, s60, v81
    s_waitcnt lgkmcnt(6)
    v_mfma_f32_16x16x32_bf16 v[112:115], v[40:43], v[160:163], v[112:115]
    ds_read_b64_tr_b16 v[36:37], v7 offset:12288
    v_add_u32 v82, s60, v82
    v_mfma_f32_16x16x32_bf16 v[116:119], v[40:43], v[164:167], v[116:119]
    ds_read_b64_tr_b16 v[38:39], v7 offset:12544
    ds_read2_b32 v[10:11], v14 offset0:128 offset1:144
    v_add_u32 v83, s60, v83
    v_mfma_f32_16x16x32_bf16 v[120:123], v[44:47], v[160:163], v[120:123]
    ds_read_b64_tr_b16 v[40:41], v6 offset:14336
    v_add_u32 v84, s60, v84
    v_mfma_f32_16x16x32_bf16 v[124:127], v[44:47], v[164:167], v[124:127]
    ds_read_b64_tr_b16 v[42:43], v6 offset:14592
    v_add_u32 v85, s60, v85
    s_waitcnt lgkmcnt(7)
    v_mfma_f32_16x16x32_bf16 v[112:115], v[24:27], v[168:171], v[112:115]
    ds_read_b64_tr_b16 v[44:45], v7 offset:14336
    v_add_u32 v86, s60, v86
    v_mfma_f32_16x16x32_bf16 v[116:119], v[24:27], v[172:175], v[116:119]
    ds_read_b64_tr_b16 v[46:47], v7 offset:14592
    v_add_u32 v87, s60, v87
    v_mfma_f32_16x16x32_bf16 v[120:123], v[28:31], v[168:171], v[120:123]
    ds_read_b64_tr_b16 v[24:25], v6 offset:16384
    v_perm_b32 v88, v81, v80, s61
    v_mfma_f32_16x16x32_bf16 v[124:127], v[28:31], v[172:175], v[124:127]
    ds_read_b64_tr_b16 v[26:27], v6 offset:16640
    v_perm_b32 v89, v83, v82, s61
    s_waitcnt lgkmcnt(7)
    v_mfma_f32_16x16x32_bf16 v[112:115], v[32:35], v[176:179], v[112:115]
    ds_read_b64_tr_b16 v[28:29], v7 offset:16384
    v_perm_b32 v90, v85, v84, s61
    v_mfma_f32_16x16x32_bf16 v[116:119], v[32:35], v[180:183], v[116:119]
    ds_read_b64_tr_b16 v[30:31], v7 offset:16640
    v_perm_b32 v91, v87, v86, s61
    v_mfma_f32_16x16x32_bf16 v[120:123], v[36:39], v[176:179], v[120:123]
    ds_read_b64_tr_b16 v[32:33], v6 offset:18432
    v_permlane16_swap_b32 v88, v90
    v_mfma_f32_16x16x32_bf16 v[124:127], v[36:39], v[180:183], v[124:127]
    ds_read_b64_tr_b16 v[34:35], v6 offset:18688
    v_permlane16_swap_b32 v89, v91
    s_waitcnt lgkmcnt(6)
    v_mfma_f32_16x16x32_bf16 v[112:115], v[40:43], v[184:187], v[112:115]
    ds_read_b64_tr_b16 v[36:37], v7 offset:18432
    v_bfi_b32 v88, s62, v2, v88
    v_mfma_f32_16x16x32_bf16 v[116:119], v[40:43], v[188:191], v[116:119]
    ds_read_b64_tr_b16 v[38:39], v7 offset:18688
    v_mov_b32 v16, v10
    v_bfi_b32 v89, s62, v2, v89
    v_mfma_f32_16x16x32_bf16 v[120:123], v[44:47], v[184:187], v[120:123]
    ds_read_b64_tr_b16 v[40:41], v6 offset:20480
    v_bfi_b32 v90, s62, v2, v90
    v_mfma_f32_16x16x32_bf16 v[124:127], v[44:47], v[188:191], v[124:127]
    ds_read_b64_tr_b16 v[42:43], v6 offset:20736
    v_mfma_f32_16x16x32_bf16 v[112:115], v[16:19], v[20:23], v[112:115]
    v_mfma_f32_16x16x32_bf16 v[116:119], v[16:19], v[22:25], v[116:119]
    v_bfi_b32 v91, s62, v2, v91
    s_waitcnt lgkmcnt(6)
    v_mfma_f32_16x16x32_bf16 v[112:115], v[24:27], v[192:195], v[112:115]
    ds_read_b64_tr_b16 v[44:45], v7 offset:20480
    buffer_store_dwordx4 v[88:91], v15, s[40:43], s56 offen offset:2048 sc1
    v_mfma_f32_16x16x32_bf16 v[116:119], v[24:27], v[196:199], v[116:119]
    ds_read_b64_tr_b16 v[46:47], v7 offset:20736
    v_mov_b32 v16, v11
    v_mfma_f32_16x16x32_bf16 v[120:123], v[28:31], v[192:195], v[120:123]
    ds_read_b64_tr_b16 v[24:25], v6 offset:22528
    v_mfma_f32_16x16x32_bf16 v[124:127], v[28:31], v[196:199], v[124:127]
    ds_read_b64_tr_b16 v[26:27], v6 offset:22784
    v_mfma_f32_16x16x32_bf16 v[120:123], v[16:19], v[20:23], v[120:123]
    v_mfma_f32_16x16x32_bf16 v[124:127], v[16:19], v[22:25], v[124:127]
    s_waitcnt lgkmcnt(6)
    v_mfma_f32_16x16x32_bf16 v[112:115], v[32:35], v[200:203], v[112:115]
    ds_read_b64_tr_b16 v[28:29], v7 offset:22528
    v_mul_f32 v96, v96, v104
    v_mfma_f32_16x16x32_bf16 v[116:119], v[32:35], v[204:207], v[116:119]
    ds_read_b64_tr_b16 v[30:31], v7 offset:22784
    v_mul_f32 v97, v97, v105
    v_mfma_f32_16x16x32_bf16 v[120:123], v[36:39], v[200:203], v[120:123]
    ds_read_b64_tr_b16 v[32:33], v6 offset:24576
    v_mul_f32 v98, v98, v106
    v_mfma_f32_16x16x32_bf16 v[124:127], v[36:39], v[204:207], v[124:127]
    ds_read_b64_tr_b16 v[34:35], v6 offset:24832
    v_mul_f32 v99, v99, v107
    s_waitcnt lgkmcnt(6)
    v_mfma_f32_16x16x32_bf16 v[112:115], v[40:43], v[208:211], v[112:115]
    ds_read_b64_tr_b16 v[36:37], v7 offset:24576
    v_mul_f32 v100, v100, v108
    v_mfma_f32_16x16x32_bf16 v[116:119], v[40:43], v[212:215], v[116:119]
    ds_read_b64_tr_b16 v[38:39], v7 offset:24832
    v_mul_f32 v101, v101, v109
    v_mfma_f32_16x16x32_bf16 v[120:123], v[44:47], v[208:211], v[120:123]
    ds_read_b64_tr_b16 v[40:41], v6 offset:26624
    v_mul_f32 v102, v102, v110
    v_mfma_f32_16x16x32_bf16 v[124:127], v[44:47], v[212:215], v[124:127]
    ds_read_b64_tr_b16 v[42:43], v6 offset:26880
    v_mul_f32 v103, v103, v111
    s_waitcnt lgkmcnt(6)
    v_mfma_f32_16x16x32_bf16 v[112:115], v[24:27], v[216:219], v[112:115]
    ds_read_b64_tr_b16 v[44:45], v7 offset:26624
    v_add_u32 v96, s60, v96
    v_mfma_f32_16x16x32_bf16 v[116:119], v[24:27], v[220:223], v[116:119]
    ds_read_b64_tr_b16 v[46:47], v7 offset:26880
    v_add_u32 v97, s60, v97
    v_mfma_f32_16x16x32_bf16 v[120:123], v[28:31], v[216:219], v[120:123]
    ds_read_b64_tr_b16 v[24:25], v6 offset:28672
    v_add_u32 v98, s60, v98
    v_mfma_f32_16x16x32_bf16 v[124:127], v[28:31], v[220:223], v[124:127]
    ds_read_b64_tr_b16 v[26:27], v6 offset:28928
    v_add_u32 v99, s60, v99
    s_waitcnt lgkmcnt(6)
    v_mfma_f32_16x16x32_bf16 v[112:115], v[32:35], v[224:227], v[112:115]
    ds_read_b64_tr_b16 v[28:29], v7 offset:28672
    v_add_u32 v100, s60, v100
    v_mfma_f32_16x16x32_bf16 v[116:119], v[32:35], v[228:231], v[116:119]
    ds_read_b64_tr_b16 v[30:31], v7 offset:28928
    v_add_u32 v101, s60, v101
    v_mfma_f32_16x16x32_bf16 v[120:123], v[36:39], v[224:227], v[120:123]
    ds_read_b64_tr_b16 v[32:33], v6 offset:30720
    v_add_u32 v102, s60, v102
    v_mfma_f32_16x16x32_bf16 v[124:127], v[36:39], v[228:231], v[124:127]
    ds_read_b64_tr_b16 v[34:35], v6 offset:30976
    v_add_u32 v103, s60, v103
    s_waitcnt lgkmcnt(6)
    v_mfma_f32_16x16x32_bf16 v[112:115], v[40:43], v[232:235], v[112:115]
    ds_read_b64_tr_b16 v[36:37], v7 offset:30720
    v_perm_b32 v104, v97, v96, s61
    v_mfma_f32_16x16x32_bf16 v[116:119], v[40:43], v[236:239], v[116:119]
    ds_read_b64_tr_b16 v[38:39], v7 offset:30976
    v_perm_b32 v105, v99, v98, s61
    v_mfma_f32_16x16x32_bf16 v[120:123], v[44:47], v[232:235], v[120:123]
    ds_read_b64_tr_b16 v[40:41], v6 offset:32768
    v_perm_b32 v106, v101, v100, s61
    v_mfma_f32_16x16x32_bf16 v[124:127], v[44:47], v[236:239], v[124:127]
    ds_read_b64_tr_b16 v[42:43], v6 offset:33024
    v_perm_b32 v107, v103, v102, s61
    s_waitcnt lgkmcnt(6)
    v_mfma_f32_16x16x32_bf16 v[112:115], v[24:27], v[240:243], v[112:115]
    ds_read_b64_tr_b16 v[44:45], v7 offset:32768
    v_permlane16_swap_b32 v104, v106
    v_mfma_f32_16x16x32_bf16 v[116:119], v[24:27], v[244:247], v[116:119]
    ds_read_b64_tr_b16 v[46:47], v7 offset:33024
    v_permlane16_swap_b32 v105, v107
    v_mfma_f32_16x16x32_bf16 v[120:123], v[28:31], v[240:243], v[120:123]
    ds_read_b64_tr_b16 v[24:25], v6 offset:34816
    v_bfi_b32 v104, s62, v2, v104
    v_mfma_f32_16x16x32_bf16 v[124:127], v[28:31], v[244:247], v[124:127]
    ds_read_b64_tr_b16 v[26:27], v6 offset:35072
    v_bfi_b32 v105, s62, v2, v105
    s_waitcnt lgkmcnt(6)
    v_mfma_f32_16x16x32_bf16 v[112:115], v[32:35], v[248:251], v[112:115]
    ds_read_b64_tr_b16 v[28:29], v7 offset:34816
    v_bfi_b32 v106, s62, v2, v106
    v_mfma_f32_16x16x32_bf16 v[116:119], v[32:35], v[252:255], v[116:119]
    ds_read_b64_tr_b16 v[30:31], v7 offset:35072
    v_bfi_b32 v107, s62, v2, v107
    v_mfma_f32_16x16x32_bf16 v[120:123], v[36:39], v[248:251], v[120:123]
    ds_read_b64_tr_b16 v[32:33], v6 offset:36864
    buffer_store_dwordx4 v[104:107], v15, s[40:43], s56 offen offset:3072 sc1
    v_mfma_f32_16x16x32_bf16 v[124:127], v[36:39], v[252:255], v[124:127]
    ds_read_b64_tr_b16 v[34:35], v6 offset:37120
    v_xor_b32 v3, 128, v8
    s_mov_b64 exec, 2
    ds_add_u32 v14, v15 offset:1116
    s_mov_b64 exec, -1
    s_waitcnt lgkmcnt(7)
    v_mfma_f32_16x16x32_bf16 v[48:51], v[40:43], v[128:131], 0
    ds_read_b64_tr_b16 v[36:37], v7 offset:36864
    v_mfma_f32_16x16x32_bf16 v[52:55], v[40:43], v[132:135], 0
    ds_read_b64_tr_b16 v[38:39], v7 offset:37120
    v_mfma_f32_16x16x32_bf16 v[56:59], v[44:47], v[128:131], 0
    ds_read_b64_tr_b16 v[40:41], v6 offset:38912
    v_mfma_f32_16x16x32_bf16 v[60:63], v[44:47], v[132:135], 0
    ds_read_b64_tr_b16 v[42:43], v6 offset:39168
    s_waitcnt lgkmcnt(7)
    v_mfma_f32_16x16x32_bf16 v[48:51], v[24:27], v[136:139], v[48:51]
    ds_read_b64_tr_b16 v[44:45], v7 offset:38912
    v_mul_f32 v112, v112, v120
    v_mfma_f32_16x16x32_bf16 v[52:55], v[24:27], v[140:143], v[52:55]
    ds_read_b64_tr_b16 v[46:47], v7 offset:39168
    v_mul_f32 v113, v113, v121
    v_mfma_f32_16x16x32_bf16 v[56:59], v[28:31], v[136:139], v[56:59]
    ds_read_b64_tr_b16 v[24:25], v6 offset:40960
    v_mul_f32 v114, v114, v122
    v_mfma_f32_16x16x32_bf16 v[60:63], v[28:31], v[140:143], v[60:63]
    ds_read_b64_tr_b16 v[26:27], v6 offset:41216
    v_mul_f32 v115, v115, v123
    s_waitcnt lgkmcnt(6)
    v_mfma_f32_16x16x32_bf16 v[48:51], v[32:35], v[144:147], v[48:51]
    ds_read_b64_tr_b16 v[28:29], v7 offset:40960
    v_mul_f32 v116, v116, v124
    v_mfma_f32_16x16x32_bf16 v[52:55], v[32:35], v[148:151], v[52:55]
    ds_read_b64_tr_b16 v[30:31], v7 offset:41216
    v_mul_f32 v117, v117, v125
    v_mfma_f32_16x16x32_bf16 v[56:59], v[36:39], v[144:147], v[56:59]
    ds_read_b64_tr_b16 v[32:33], v6 offset:43008
    v_mul_f32 v118, v118, v126
    v_mfma_f32_16x16x32_bf16 v[60:63], v[36:39], v[148:151], v[60:63]
    ds_read_b64_tr_b16 v[34:35], v6 offset:43264
    v_mul_f32 v119, v119, v127
    s_waitcnt lgkmcnt(6)
    v_mfma_f32_16x16x32_bf16 v[48:51], v[40:43], v[152:155], v[48:51]
    ds_read_b64_tr_b16 v[36:37], v7 offset:43008
    v_add_u32 v112, s60, v112
    v_mfma_f32_16x16x32_bf16 v[52:55], v[40:43], v[156:159], v[52:55]
    ds_read_b64_tr_b16 v[38:39], v7 offset:43264
    v_add_u32 v113, s60, v113
    v_mfma_f32_16x16x32_bf16 v[56:59], v[44:47], v[152:155], v[56:59]
    ds_read_b64_tr_b16 v[40:41], v6 offset:45056
    v_add_u32 v114, s60, v114
    v_mfma_f32_16x16x32_bf16 v[60:63], v[44:47], v[156:159], v[60:63]
    ds_read_b64_tr_b16 v[42:43], v6 offset:45312
    v_add_u32 v115, s60, v115
    s_waitcnt lgkmcnt(6)
    v_mfma_f32_16x16x32_bf16 v[48:51], v[24:27], v[160:163], v[48:51]
    ds_read_b64_tr_b16 v[44:45], v7 offset:45056
    v_add_u32 v116, s60, v116
    v_mfma_f32_16x16x32_bf16 v[52:55], v[24:27], v[164:167], v[52:55]
    ds_read_b64_tr_b16 v[46:47], v7 offset:45312
    ds_read2_b32 v[12:13], v14 offset0:160 offset1:176
    v_add_u32 v117, s60, v117
    v_mfma_f32_16x16x32_bf16 v[56:59], v[28:31], v[160:163], v[56:59]
    ds_read_b64_tr_b16 v[24:25], v6 offset:47104
    v_add_u32 v118, s60, v118
    v_mfma_f32_16x16x32_bf16 v[60:63], v[28:31], v[164:167], v[60:63]
    ds_read_b64_tr_b16 v[26:27], v6 offset:47360
    v_add_u32 v119, s60, v119
    s_waitcnt lgkmcnt(7)
    v_mfma_f32_16x16x32_bf16 v[48:51], v[32:35], v[168:171], v[48:51]
    ds_read_b64_tr_b16 v[28:29], v7 offset:47104
    v_perm_b32 v120, v113, v112, s61
    v_mfma_f32_16x16x32_bf16 v[52:55], v[32:35], v[172:175], v[52:55]
    ds_read_b64_tr_b16 v[30:31], v7 offset:47360
    v_perm_b32 v121, v115, v114, s61
    v_mfma_f32_16x16x32_bf16 v[56:59], v[36:39], v[168:171], v[56:59]
    ds_read_b64_tr_b16 v[32:33], v6 offset:49152
    v_perm_b32 v122, v117, v116, s61
    v_mfma_f32_16x16x32_bf16 v[60:63], v[36:39], v[172:175], v[60:63]
    ds_read_b64_tr_b16 v[34:35], v6 offset:49408
    v_perm_b32 v123, v119, v118, s61
    s_mov_b64 exec, 2
    ds_add_u32 v14, v15 offset:1120
    s_mov_b64 exec, -1
    s_waitcnt lgkmcnt(8)
    v_mfma_f32_16x16x32_bf16 v[48:51], v[40:43], v[176:179], v[48:51]
    ds_read_b64_tr_b16 v[36:37], v7 offset:49152
    v_permlane16_swap_b32 v120, v122
    v_mfma_f32_16x16x32_bf16 v[52:55], v[40:43], v[180:183], v[52:55]
    ds_read_b64_tr_b16 v[38:39], v7 offset:49408
    v_permlane16_swap_b32 v121, v123
    v_mfma_f32_16x16x32_bf16 v[56:59], v[44:47], v[176:179], v[56:59]
    ds_read_b64_tr_b16 v[40:41], v6 offset:51200
    v_bfi_b32 v120, s62, v2, v120
    v_mfma_f32_16x16x32_bf16 v[60:63], v[44:47], v[180:183], v[60:63]
    ds_read_b64_tr_b16 v[42:43], v6 offset:51456
    v_bfi_b32 v121, s62, v2, v121
    s_waitcnt lgkmcnt(7)
    v_mfma_f32_16x16x32_bf16 v[48:51], v[24:27], v[184:187], v[48:51]
    ds_read_b64_tr_b16 v[44:45], v7 offset:51200
    v_bfi_b32 v122, s62, v2, v122
    v_mfma_f32_16x16x32_bf16 v[52:55], v[24:27], v[188:191], v[52:55]
    ds_read_b64_tr_b16 v[46:47], v7 offset:51456
    v_mov_b32 v16, v12
    v_bfi_b32 v123, s62, v2, v123
    v_mfma_f32_16x16x32_bf16 v[56:59], v[28:31], v[184:187], v[56:59]
    ds_read_b64_tr_b16 v[24:25], v6 offset:53248
    buffer_store_dwordx4 v[120:123], v15, s[40:43], s57 offen offset:0 sc1
    v_mfma_f32_16x16x32_bf16 v[60:63], v[28:31], v[188:191], v[60:63]
    ds_read_b64_tr_b16 v[26:27], v6 offset:53504
    v_mfma_f32_16x16x32_bf16 v[48:51], v[16:19], v[20:23], v[48:51]
    v_mfma_f32_16x16x32_bf16 v[52:55], v[16:19], v[22:25], v[52:55]
    s_waitcnt lgkmcnt(6)
    v_mfma_f32_16x16x32_bf16 v[48:51], v[32:35], v[192:195], v[48:51]
    ds_read_b64_tr_b16 v[28:29], v7 offset:53248
    v_mfma_f32_16x16x32_bf16 v[52:55], v[32:35], v[196:199], v[52:55]
    ds_read_b64_tr_b16 v[30:31], v7 offset:53504
    v_mov_b32 v16, v13
    v_mfma_f32_16x16x32_bf16 v[56:59], v[36:39], v[192:195], v[56:59]
    ds_read_b64_tr_b16 v[32:33], v6 offset:55296
    v_mfma_f32_16x16x32_bf16 v[60:63], v[36:39], v[196:199], v[60:63]
    ds_read_b64_tr_b16 v[34:35], v6 offset:55552
    v_mfma_f32_16x16x32_bf16 v[56:59], v[16:19], v[20:23], v[56:59]
    v_mfma_f32_16x16x32_bf16 v[60:63], v[16:19], v[22:25], v[60:63]
    s_waitcnt lgkmcnt(6)
    v_mfma_f32_16x16x32_bf16 v[48:51], v[40:43], v[200:203], v[48:51]
    ds_read_b64_tr_b16 v[36:37], v7 offset:55296
    v_mfma_f32_16x16x32_bf16 v[52:55], v[40:43], v[204:207], v[52:55]
    ds_read_b64_tr_b16 v[38:39], v7 offset:55552
    ds_read_b32 v0, v14 offset:1084
    v_mfma_f32_16x16x32_bf16 v[56:59], v[44:47], v[200:203], v[56:59]
    ds_read_b64_tr_b16 v[40:41], v6 offset:57344
    v_mfma_f32_16x16x32_bf16 v[60:63], v[44:47], v[204:207], v[60:63]
    ds_read_b64_tr_b16 v[42:43], v6 offset:57600
    s_waitcnt lgkmcnt(7)
    v_mfma_f32_16x16x32_bf16 v[48:51], v[24:27], v[208:211], v[48:51]
    ds_read_b64_tr_b16 v[44:45], v7 offset:57344
    v_mfma_f32_16x16x32_bf16 v[52:55], v[24:27], v[212:215], v[52:55]
    ds_read_b64_tr_b16 v[46:47], v7 offset:57600
    v_mfma_f32_16x16x32_bf16 v[56:59], v[28:31], v[208:211], v[56:59]
    ds_read_b64_tr_b16 v[24:25], v6 offset:59392
    v_mfma_f32_16x16x32_bf16 v[60:63], v[28:31], v[212:215], v[60:63]
    ds_read_b64_tr_b16 v[26:27], v6 offset:59648
    s_waitcnt lgkmcnt(7)
    v_mfma_f32_16x16x32_bf16 v[48:51], v[32:35], v[216:219], v[48:51]
    ds_read_b64_tr_b16 v[28:29], v7 offset:59392
    v_mfma_f32_16x16x32_bf16 v[52:55], v[32:35], v[220:223], v[52:55]
    ds_read_b64_tr_b16 v[30:31], v7 offset:59648
    v_mfma_f32_16x16x32_bf16 v[56:59], v[36:39], v[216:219], v[56:59]
    ds_read_b64_tr_b16 v[32:33], v6 offset:61440
    v_mfma_f32_16x16x32_bf16 v[60:63], v[36:39], v[220:223], v[60:63]
    ds_read_b64_tr_b16 v[34:35], v6 offset:61696
    s_waitcnt lgkmcnt(6)
    v_mfma_f32_16x16x32_bf16 v[48:51], v[40:43], v[224:227], v[48:51]
    ds_read_b64_tr_b16 v[36:37], v7 offset:61440
    v_mfma_f32_16x16x32_bf16 v[52:55], v[40:43], v[228:231], v[52:55]
    ds_read_b64_tr_b16 v[38:39], v7 offset:61696
    v_readfirstlane_b32 s58, v0
    v_mfma_f32_16x16x32_bf16 v[56:59], v[44:47], v[224:227], v[56:59]
    ds_read_b64_tr_b16 v[40:41], v6 offset:63488
    v_mfma_f32_16x16x32_bf16 v[60:63], v[44:47], v[228:231], v[60:63]
    ds_read_b64_tr_b16 v[42:43], v6 offset:63744
    s_waitcnt lgkmcnt(6)
    v_mfma_f32_16x16x32_bf16 v[48:51], v[24:27], v[232:235], v[48:51]
    ds_read_b64_tr_b16 v[44:45], v7 offset:63488
    v_mfma_f32_16x16x32_bf16 v[52:55], v[24:27], v[236:239], v[52:55]
    ds_read_b64_tr_b16 v[46:47], v7 offset:63744
    s_cmp_lt_u32 s58, 4
    s_cbranch_scc1 L_w_p2
L_w_p2_ok:
    v_mfma_f32_16x16x32_bf16 v[56:59], v[28:31], v[232:235], v[56:59]
    ds_read_b64_tr_b16 v[24:25], v8 offset:0
    v_mfma_f32_16x16x32_bf16 v[60:63], v[28:31], v[236:239], v[60:63]
    ds_read_b64_tr_b16 v[26:27], v8 offset:256
    s_waitcnt lgkmcnt(6)
    v_mfma_f32_16x16x32_bf16 v[48:51], v[32:35], v[240:243], v[48:51]
    ds_read_b64_tr_b16 v[28:29], v3 offset:0
    v_mfma_f32_16x16x32_bf16 v[52:55], v[32:35], v[244:247], v[52:55]
    ds_read_b64_tr_b16 v[30:31], v3 offset:256
    v_mfma_f32_16x16x32_bf16 v[56:59], v[36:39], v[240:243], v[56:59]
    ds_read_b64_tr_b16 v[32:33], v8 offset:2048
    v_mfma_f32_16x16x32_bf16 v[60:63], v[36:39], v[244:247], v[60:63]
    ds_read_b64_tr_b16 v[34:35], v8 offset:2304
    s_waitcnt lgkmcnt(6)
    v_mfma_f32_16x16x32_bf16 v[48:51], v[40:43], v[248:251], v[48:51]
    ds_read_b64_tr_b16 v[36:37], v3 offset:2048
    v_mfma_f32_16x16x32_bf16 v[52:55], v[40:43], v[252:255], v[52:55]
    ds_read_b64_tr_b16 v[38:39], v3 offset:2304
    v_mfma_f32_16x16x32_bf16 v[56:59], v[44:47], v[248:251], v[56:59]
    ds_read_b64_tr_b16 v[40:41], v8 offset:4096
    v_mfma_f32_16x16x32_bf16 v[60:63], v[44:47], v[252:255], v[60:63]
    ds_read_b64_tr_b16 v[42:43], v8 offset:4352
    s_waitcnt lgkmcnt(6)
    v_mfma_f32_16x16x32_bf16 v[64:67], v[24:27], v[128:131], 0
    ds_read_b64_tr_b16 v[44:45], v3 offset:4096
    v_mfma_f32_16x16x32_bf16 v[68:71], v[24:27], v[132:135], 0
    ds_read_b64_tr_b16 v[46:47], v3 offset:4352
    v_mfma_f32_16x16x32_bf16 v[72:75], v[28:31], v[128:131], 0
    ds_read_b64_tr_b16 v[24:25], v8 offset:6144
    v_mfma_f32_16x16x32_bf16 v[76:79], v[28:31], v[132:135], 0
    ds_read_b64_tr_b16 v[26:27], v8 offset:6400
    s_waitcnt lgkmcnt(6)
    v_mfma_f32_16x16x32_bf16 v[64:67], v[32:35], v[136:139], v[64:67]
    ds_read_b64_tr_b16 v[28:29], v3 offset:6144
    v_mul_f32 v48, v48, v56
    v_mfma_f32_16x16x32_bf16 v[68:71], v[32:35], v[140:143], v[68:71]
    ds_read_b64_tr_b16 v[30:31], v3 offset:6400
    v_mul_f32 v49, v49, v57
    v_mfma_f32_16x16x32_bf16 v[72:75], v[36:39], v[136:139], v[72:75]
    ds_read_b64_tr_b16 v[32:33], v8 offset:8192
    v_mul_f32 v50, v50, v58
    v_mfma_f32_16x16x32_bf16 v[76:79], v[36:39], v[140:143], v[76:79]
    ds_read_b64_tr_b16 v[34:35], v8 offset:8448
    v_mul_f32 v51, v51, v59
    s_waitcnt lgkmcnt(6)
    v_mfma_f32_16x16x32_bf16 v[64:67], v[40:43], v[144:147], v[64:67]
    ds_read_b64_tr_b16 v[36:37], v3 offset:8192
    v_mul_f32 v52, v52, v60
    v_mfma_f32_16x16x32_bf16 v[68:71], v[40:43], v[148:151], v[68:71]
    ds_read_b64_tr_b16 v[38:39], v3 offset:8448
    v_mul_f32 v53, v53, v61
    v_mfma_f32_16x16x32_bf16 v[72:75], v[44:47], v[144:147], v[72:75]
    ds_read_b64_tr_b16 v[40:41], v8 offset:10240
    v_mul_f32 v54, v54, v62
    v_mfma_f32_16x16x32_bf16 v[76:79], v[44:47], v[148:151], v[76:79]
    ds_read_b64_tr_b16 v[42:43], v8 offset:10496
    v_mul_f32 v55, v55, v63
    s_mov_b64 exec, 2
    ds_add_u32 v14, v15 offset:1124
    s_mov_b64 exec, -1
    s_waitcnt lgkmcnt(7)
    v_mfma_f32_16x16x32_bf16 v[64:67], v[24:27], v[152:155], v[64:67]
    ds_read_b64_tr_b16 v[44:45], v3 offset:10240
    v_add_u32 v48, s60, v48
    v_mfma_f32_16x16x32_bf16 v[68:71], v[24:27], v[156:159], v[68:71]
    ds_read_b64_tr_b16 v[46:47], v3 offset:10496
    v_add_u32 v49, s60, v49
    v_mfma_f32_16x16x32_bf16 v[72:75], v[28:31], v[152:155], v[72:75]
    ds_read_b64_tr_b16 v[24:25], v8 offset:12288
    v_add_u32 v50, s60, v50
    v_mfma_f32_16x16x32_bf16 v[76:79], v[28:31], v[156:159], v[76:79]
    ds_read_b64_tr_b16 v[26:27], v8 offset:12544
    v_add_u32 v51, s60, v51
    s_waitcnt lgkmcnt(7)
    v_mfma_f32_16x16x32_bf16 v[64:67], v[32:35], v[160:163], v[64:67]
    ds_read_b64_tr_b16 v[28:29], v3 offset:12288
    v_add_u32 v52, s60, v52
    v_mfma_f32_16x16x32_bf16 v[68:71], v[32:35], v[164:167], v[68:71]
    ds_read_b64_tr_b16 v[30:31], v3 offset:12544
    ds_read2_b32 v[10:11], v14 offset0:192 offset1:208
    v_add_u32 v53, s60, v53
    v_mfma_f32_16x16x32_bf16 v[72:75], v[36:39], v[160:163], v[72:75]
    ds_read_b64_tr_b16 v[32:33], v8 offset:14336
    v_add_u32 v54, s60, v54
    v_mfma_f32_16x16x32_bf16 v[76:79], v[36:39], v[164:167], v[76:79]
    ds_read_b64_tr_b16 v[34:35], v8 offset:14592
    v_add_u32 v55, s60, v55
    s_waitcnt lgkmcnt(7)
    v_mfma_f32_16x16x32_bf16 v[64:67], v[40:43], v[168:171], v[64:67]
    ds_read_b64_tr_b16 v[36:37], v3 offset:14336
    v_perm_b32 v56, v49, v48, s61
    v_mfma_f32_16x16x32_bf16 v[68:71], v[40:43], v[172:175], v[68:71]
    ds_read_b64_tr_b16 v[38:39], v3 offset:14592
    v_perm_b32 v57, v51, v50, s61
    v_mfma_f32_16x16x32_bf16 v[72:75], v[44:47], v[168:171], v[72:75]
    ds_read_b64_tr_b16 v[40:41], v8 offset:16384
    v_perm_b32 v58, v53, v52, s61
    v_mfma_f32_16x16x32_bf16 v[76:79], v[44:47], v[172:175], v[76:79]
    ds_read_b64_tr_b16 v[42:43], v8 offset:16640
    v_perm_b32 v59, v55, v54, s61
    s_waitcnt lgkmcnt(7)
    v_mfma_f32_16x16x32_bf16 v[64:67], v[24:27], v[176:179], v[64:67]
    ds_read_b64_tr_b16 v[44:45], v3 offset:16384
    v_permlane16_swap_b32 v56, v58
    v_mfma_f32_16x16x32_bf16 v[68:71], v[24:27], v[180:183], v[68:71]
    ds_read_b64_tr_b16 v[46:47], v3 offset:16640
    v_permlane16_swap_b32 v57, v59
    v_mfma_f32_16x16x32_bf16 v[72:75], v[28:31], v[176:179], v[72:75]
    ds_read_b64_tr_b16 v[24:25], v8 offset:18432
    v_bfi_b32 v56, s62, v2, v56
    v_mfma_f32_16x16x32_bf16 v[76:79], v[28:31], v[180:183], v[76:79]
    ds_read_b64_tr_b16 v[26:27], v8 offset:18688
    v_bfi_b32 v57, s62, v2, v57
    s_waitcnt lgkmcnt(6)
    v_mfma_f32_16x16x32_bf16 v[64:67], v[32:35], v[184:187], v[64:67]
    ds_read_b64_tr_b16 v[28:29], v3 offset:18432
    v_bfi_b32 v58, s62, v2, v58
    v_mfma_f32_16x16x32_bf16 v[68:71], v[32:35], v[188:191], v[68:71]
    ds_read_b64_tr_b16 v[30:31], v3 offset:18688
    v_mov_b32 v16, v10
    v_bfi_b32 v59, s62, v2, v59
    v_mfma_f32_16x16x32_bf16 v[72:75], v[36:39], v[184:187], v[72:75]
    ds_read_b64_tr_b16 v[32:33], v8 offset:20480
    buffer_store_dwordx4 v[56:59], v15, s[40:43], s57 offen offset:1024 sc1
    v_mfma_f32_16x16x32_bf16 v[76:79], v[36:39], v[188:191], v[76:79]
    ds_read_b64_tr_b16 v[34:35], v8 offset:20736
    v_mfma_f32_16x16x32_bf16 v[64:67], v[16:19], v[20:23], v[64:67]
    v_mfma_f32_16x16x32_bf16 v[68:71], v[16:19], v[22:25], v[68:71]
    s_waitcnt lgkmcnt(6)
    v_mfma_f32_16x16x32_bf16 v[64:67], v[40:43], v[192:195], v[64:67]
    ds_read_b64_tr_b16 v[36:37], v3 offset:20480
    v_mfma_f32_16x16x32_bf16 v[68:71], v[40:43], v[196:199], v[68:71]
    ds_read_b64_tr_b16 v[38:39], v3 offset:20736
    v_mov_b32 v16, v11
    v_mfma_f32_16x16x32_bf16 v[72:75], v[44:47], v[192:195], v[72:75]
    ds_read_b64_tr_b16 v[40:41], v8 offset:22528
    v_mfma_f32_16x16x32_bf16 v[76:79], v[44:47], v[196:199], v[76:79]
    ds_read_b64_tr_b16 v[42:43], v8 offset:22784
    v_mfma_f32_16x16x32_bf16 v[72:75], v[16:19], v[20:23], v[72:75]
    v_mfma_f32_16x16x32_bf16 v[76:79], v[16:19], v[22:25], v[76:79]
    s_waitcnt lgkmcnt(6)
    v_mfma_f32_16x16x32_bf16 v[64:67], v[24:27], v[200:203], v[64:67]
    ds_read_b64_tr_b16 v[44:45], v3 offset:22528
    v_mfma_f32_16x16x32_bf16 v[68:71], v[24:27], v[204:207], v[68:71]
    ds_read_b64_tr_b16 v[46:47], v3 offset:22784
    v_mfma_f32_16x16x32_bf16 v[72:75], v[28:31], v[200:203], v[72:75]
    ds_read_b64_tr_b16 v[24:25], v8 offset:24576
    v_mfma_f32_16x16x32_bf16 v[76:79], v[28:31], v[204:207], v[76:79]
    ds_read_b64_tr_b16 v[26:27], v8 offset:24832
    s_waitcnt lgkmcnt(6)
    v_mfma_f32_16x16x32_bf16 v[64:67], v[32:35], v[208:211], v[64:67]
    ds_read_b64_tr_b16 v[28:29], v3 offset:24576
    v_mfma_f32_16x16x32_bf16 v[68:71], v[32:35], v[212:215], v[68:71]
    ds_read_b64_tr_b16 v[30:31], v3 offset:24832
    v_mfma_f32_16x16x32_bf16 v[72:75], v[36:39], v[208:211], v[72:75]
    ds_read_b64_tr_b16 v[32:33], v8 offset:26624
    v_mfma_f32_16x16x32_bf16 v[76:79], v[36:39], v[212:215], v[76:79]
    ds_read_b64_tr_b16 v[34:35], v8 offset:26880
    s_waitcnt lgkmcnt(6)
    v_mfma_f32_16x16x32_bf16 v[64:67], v[40:43], v[216:219], v[64:67]
    ds_read_b64_tr_b16 v[36:37], v3 offset:26624
    v_mfma_f32_16x16x32_bf16 v[68:71], v[40:43], v[220:223], v[68:71]
    ds_read_b64_tr_b16 v[38:39], v3 offset:26880
    v_mfma_f32_16x16x32_bf16 v[72:75], v[44:47], v[216:219], v[72:75]
    ds_read_b64_tr_b16 v[40:41], v8 offset:28672
    v_mfma_f32_16x16x32_bf16 v[76:79], v[44:47], v[220:223], v[76:79]
    ds_read_b64_tr_b16 v[42:43], v8 offset:28928
    s_waitcnt lgkmcnt(6)
    v_mfma_f32_16x16x32_bf16 v[64:67], v[24:27], v[224:227], v[64:67]
    ds_read_b64_tr_b16 v[44:45], v3 offset:28672
    v_mfma_f32_16x16x32_bf16 v[68:71], v[24:27], v[228:231], v[68:71]
    ds_read_b64_tr_b16 v[46:47], v3 offset:28928
    v_mfma_f32_16x16x32_bf16 v[72:75], v[28:31], v[224:227], v[72:75]
    ds_read_b64_tr_b16 v[24:25], v8 offset:30720
    v_mfma_f32_16x16x32_bf16 v[76:79], v[28:31], v[228:231], v[76:79]
    ds_read_b64_tr_b16 v[26:27], v8 offset:30976
    s_waitcnt lgkmcnt(6)
    v_mfma_f32_16x16x32_bf16 v[64:67], v[32:35], v[232:235], v[64:67]
    ds_read_b64_tr_b16 v[28:29], v3 offset:30720
    v_mfma_f32_16x16x32_bf16 v[68:71], v[32:35], v[236:239], v[68:71]
    ds_read_b64_tr_b16 v[30:31], v3 offset:30976
    v_mfma_f32_16x16x32_bf16 v[72:75], v[36:39], v[232:235], v[72:75]
    v_mfma_f32_16x16x32_bf16 v[76:79], v[36:39], v[236:239], v[76:79]
    s_waitcnt lgkmcnt(4)
    v_mfma_f32_16x16x32_bf16 v[64:67], v[40:43], v[240:243], v[64:67]
    v_mfma_f32_16x16x32_bf16 v[68:71], v[40:43], v[244:247], v[68:71]
    v_mfma_f32_16x16x32_bf16 v[72:75], v[44:47], v[240:243], v[72:75]
    v_mfma_f32_16x16x32_bf16 v[76:79], v[44:47], v[244:247], v[76:79]
    s_waitcnt lgkmcnt(0)
    v_mfma_f32_16x16x32_bf16 v[64:67], v[24:27], v[248:251], v[64:67]
    v_mfma_f32_16x16x32_bf16 v[68:71], v[24:27], v[252:255], v[68:71]
    v_mfma_f32_16x16x32_bf16 v[72:75], v[28:31], v[248:251], v[72:75]
    v_mfma_f32_16x16x32_bf16 v[76:79], v[28:31], v[252:255], v[76:79]
    s_mov_b64 exec, 2
    ds_add_u32 v14, v15 offset:1128
    s_mov_b64 exec, -1
    s_nop 3
    v_mul_f32 v64, v64, v72
    v_mul_f32 v65, v65, v73
    v_mul_f32 v66, v66, v74
    v_mul_f32 v67, v67, v75
    v_mul_f32 v68, v68, v76
    v_mul_f32 v69, v69, v77
    v_mul_f32 v70, v70, v78
    v_mul_f32 v71, v71, v79
    v_add_u32 v64, s60, v64
    v_add_u32 v65, s60, v65
    v_add_u32 v66, s60, v66
    v_add_u32 v67, s60, v67
    v_add_u32 v68, s60, v68
    v_add_u32 v69, s60, v69
    v_add_u32 v70, s60, v70
    v_add_u32 v71, s60, v71
    v_perm_b32 v72, v65, v64, s61
    v_perm_b32 v73, v67, v66, s61
    v_perm_b32 v74, v69, v68, s61
    v_perm_b32 v75, v71, v70, s61
    s_nop 0
    v_permlane16_swap_b32 v72, v74
    v_permlane16_swap_b32 v73, v75
    v_bfi_b32 v72, s62, v2, v72
    v_bfi_b32 v73, s62, v2, v73
    v_bfi_b32 v74, s62, v2, v74
    v_bfi_b32 v75, s62, v2, v75
    buffer_store_dwordx4 v[72:75], v15, s[40:43], s57 offen offset:2048 sc1
    s_and_b32 s58, s66, 1
    s_lshr_b32 s60, s4, 1
    s_cmp_lg_u32 s60, s58
    s_cbranch_scc1 L_c_nors
    v_mov_b32 v24, 0
    v_mov_b32 v25, 0
    v_mov_b32 v26, 0
    v_mov_b32 v27, 0
    v_dot2c_f32_bf16 v24, v128, v128
    v_dot2c_f32_bf16 v25, v129, v129
    v_dot2c_f32_bf16 v24, v130, v130
    v_dot2c_f32_bf16 v25, v131, v131
    v_dot2c_f32_bf16 v26, v132, v132
    v_dot2c_f32_bf16 v27, v133, v133
    v_dot2c_f32_bf16 v26, v134, v134
    v_dot2c_f32_bf16 v27, v135, v135
    v_dot2c_f32_bf16 v24, v136, v136
    v_dot2c_f32_bf16 v25, v137, v137
    v_dot2c_f32_bf16 v24, v138, v138
    v_dot2c_f32_bf16 v25, v139, v139
    v_dot2c_f32_bf16 v26, v140, v140
    v_dot2c_f32_bf16 v27, v141, v141
    v_dot2c_f32_bf16 v26, v142, v142
    v_dot2c_f32_bf16 v27, v143, v143
    v_dot2c_f32_bf16 v24, v144, v144
    v_dot2c_f32_bf16 v25, v145, v145
    v_dot2c_f32_bf16 v24, v146, v146
    v_dot2c_f32_bf16 v25, v147, v147
    v_dot2c_f32_bf16 v26, v148, v148
    v_dot2c_f32_bf16 v27, v149, v149
    v_dot2c_f32_bf16 v26, v150, v150
    v_dot2c_f32_bf16 v27, v151, v151
    v_dot2c_f32_bf16 v24, v152, v152
    v_dot2c_f32_bf16 v25, v153, v153
    v_dot2c_f32_bf16 v24, v154, v154
    v_dot2c_f32_bf16 v25, v155, v155
    v_dot2c_f32_bf16 v26, v156, v156
    v_dot2c_f32_bf16 v27, v157, v157
    v_dot2c_f32_bf16 v26, v158, v158
    v_dot2c_f32_bf16 v27, v159, v159
    v_dot2c_f32_bf16 v24, v160, v160
    v_dot2c_f32_bf16 v25, v161, v161
    v_dot2c_f32_bf16 v24, v162, v162
    v_dot2c_f32_bf16 v25, v163, v163
    v_dot2c_f32_bf16 v26, v164, v164
    v_dot2c_f32_bf16 v27, v165, v165
    v_dot2c_f32_bf16 v26, v166, v166
    v_dot2c_f32_bf16 v27, v167, v167
    v_dot2c_f32_bf16 v24, v168, v168
    v_dot2c_f32_bf16 v25, v169, v169
    v_dot2c_f32_bf16 v24, v170, v170
    v_dot2c_f32_bf16 v25, v171, v171
    v_dot2c_f32_bf16 v26, v172, v172
    v_dot2c_f32_bf16 v27, v173, v173
    v_dot2c_f32_bf16 v26, v174, v174
    v_dot2c_f32_bf16 v27, v175, v175
    v_dot2c_f32_bf16 v24, v176, v176
    v_dot2c_f32_bf16 v25, v177, v177
    v_dot2c_f32_bf16 v24, v178, v178
    v_dot2c_f32_bf16 v25, v179, v179
    v_dot2c_f32_bf16 v26, v180, v180
    v_dot2c_f32_bf16 v27, v181, v181
    v_dot2c_f32_bf16 v26, v182, v182
    v_dot2c_f32_bf16 v27, v183, v183
    v_dot2c_f32_bf16 v24, v184, v184
    v_dot2c_f32_bf16 v25, v185, v185
    v_dot2c_f32_bf16 v24, v186, v186
    v_dot2c_f32_bf16 v25, v187, v187
    v_dot2c_f32_bf16 v26, v188, v188
    v_dot2c_f32_bf16 v27, v189, v189
    v_dot2c_f32_bf16 v26, v190, v190
    v_dot2c_f32_bf16 v27, v191, v191
    v_dot2c_f32_bf16 v24, v192, v192
    v_dot2c_f32_bf16 v25, v193, v193
    v_dot2c_f32_bf16 v24, v194, v194
    v_dot2c_f32_bf16 v25, v195, v195
    v_dot2c_f32_bf16 v26, v196, v196
    v_dot2c_f32_bf16 v27, v197, v197
    v_dot2c_f32_bf16 v26, v198, v198
    v_dot2c_f32_bf16 v27, v199, v199
    v_dot2c_f32_bf16 v24, v200, v200
    v_dot2c_f32_bf16 v25, v201, v201
    v_dot2c_f32_bf16 v24, v202, v202
    v_dot2c_f32_bf16 v25, v203, v203
    v_dot2c_f32_bf16 v26, v204, v204
    v_dot2c_f32_bf16 v27, v205, v205
    v_dot2c_f32_bf16 v26, v206, v206
    v_dot2c_f32_bf16 v27, v207, v207
    v_dot2c_f32_bf16 v24, v208, v208
    v_dot2c_f32_bf16 v25, v209, v209
    v_dot2c_f32_bf16 v24, v210, v210
    v_dot2c_f32_bf16 v25, v211, v211
    v_dot2c_f32_bf16 v26, v212, v212
    v_dot2c_f32_bf16 v27, v213, v213
    v_dot2c_f32_bf16 v26, v214, v214
    v_dot2c_f32_bf16 v27, v215, v215
    v_dot2c_f32_bf16 v24, v216, v216
    v_dot2c_f32_bf16 v25, v217, v217
    v_dot2c_f32_bf16 v24, v218, v218
    v_dot2c_f32_bf16 v25, v219, v219
    v_dot2c_f32_bf16 v26, v220, v220
    v_dot2c_f32_bf16 v27, v221, v221
    v_dot2c_f32_bf16 v26, v222, v222
    v_dot2c_f32_bf16 v27, v223, v223
    v_dot2c_f32_bf16 v24, v224, v224
    v_dot2c_f32_bf16 v25, v225, v225
    v_dot2c_f32_bf16 v24, v226, v226
    v_dot2c_f32_bf16 v25, v227, v227
    v_dot2c_f32_bf16 v26, v228, v228
    v_dot2c_f32_bf16 v27, v229, v229
    v_dot2c_f32_bf16 v26, v230, v230
    v_dot2c_f32_bf16 v27, v231, v231
    v_dot2c_f32_bf16 v24, v232, v232
    v_dot2c_f32_bf16 v25, v233, v233
    v_dot2c_f32_bf16 v24, v234, v234
    v_dot2c_f32_bf16 v25, v235, v235
    v_dot2c_f32_bf16 v26, v236, v236
    v_dot2c_f32_bf16 v27, v237, v237
    v_dot2c_f32_bf16 v26, v238, v238
    v_dot2c_f32_bf16 v27, v239, v239
    v_dot2c_f32_bf16 v24, v240, v240
    v_dot2c_f32_bf16 v25, v241, v241
    v_dot2c_f32_bf16 v24, v242, v242
    v_dot2c_f32_bf16 v25, v243, v243
    v_dot2c_f32_bf16 v26, v244, v244
    v_dot2c_f32_bf16 v27, v245, v245
    v_dot2c_f32_bf16 v26, v246, v246
    v_dot2c_f32_bf16 v27, v247, v247
    v_dot2c_f32_bf16 v24, v248, v248
    v_dot2c_f32_bf16 v25, v249, v249
    v_dot2c_f32_bf16 v24, v250, v250
    v_dot2c_f32_bf16 v25, v251, v251
    v_dot2c_f32_bf16 v26, v252, v252
    v_dot2c_f32_bf16 v27, v253, v253
    v_dot2c_f32_bf16 v26, v254, v254
    v_dot2c_f32_bf16 v27, v255, v255
    s_waitcnt vmcnt(0)
    s_mov_b64 exec, 2
    ds_add_u32 v14, v15 offset:1132
    s_mov_b64 exec, -1
    v_and_b32 v6, 7, v1
    v_lshlrev_b32 v6, 15, v6
    v_lshrrev_b32 v5, 3, v1
    v_lshl_add_u32 v6, v5, 2, v6
    s_lshl_b32 s62, s65, 1
    s_and_b32 s3, s66, 1
    s_add_u32 s62, s62, s3
    s_lshl_b32 s62, s62, 8
    s_lshl_b32 s3, s4, 5
    s_add_u32 s62, s62, s3
    s_lshr_b32 s3, s66, 1
    s_xor_b32 s3, s3, 1
    s_lshl_b32 s3, s3, 18
    s_add_u32 s62, s62, s3
    s_add_u32 s62, s62, 0x400000
    s_add_u32 s3, s62, 0
    buffer_load_dword v32, v6, s[40:43], s3 offen sc1
    s_add_u32 s3, s62, 8192
    buffer_load_dword v33, v6, s[40:43], s3 offen sc1
    s_add_u32 s3, s62, 16384
    buffer_load_dword v34, v6, s[40:43], s3 offen sc1
    s_add_u32 s3, s62, 24576
    buffer_load_dword v35, v6, s[40:43], s3 offen sc1
    v_add_f32 v24, v24, v25
    v_add_f32 v26, v26, v27
    s_nop 1
    v_permlane16_swap_b32 v24, v26
    v_add_f32 v24, v24, v26
    v_mov_b32 v25, v24
    s_nop 1
    v_permlane32_swap_b32 v24, v25
    v_add_f32 v24, v24, v25
    v_mul_f32 v24, 0x3b000000, v24
    v_fma_f32 v24, -v9, v9, v24
    v_max_f32 v24, 0, v24
    v_cvt_pk_bf16_f32 v24, v24, v24
    v_lshlrev_b32 v24, 16, v24
    v_add_f32 v24, 0x3727c5ac, v24
    v_cvt_pk_bf16_f32 v24, v24, v24
    v_lshlrev_b32 v24, 16, v24
    v_sqrt_f32 v24, v24
    s_nop 0
    v_cvt_pk_bf16_f32 v24, v24, v24
    v_lshlrev_b32 v24, 16, v24
    v_rcp_f32 v24, v24
    s_nop 0
    v_mul_f32 v24, v24, v24
    s_and_b32 s3, s4, 1
    s_lshl_b32 s3, s3, 7
    s_add_u32 s3, s3, 161792
    v_and_b32 v2, 31, v1
    v_lshl_add_u32 v2, v2, 2, s3
    ds_write_b32 v2, v24
    s_branch L_c_rs
L_c_nors:
    s_waitcnt vmcnt(0)
    s_mov_b64 exec, 2
    ds_add_u32 v14, v15 offset:1132
    s_mov_b64 exec, -1
    v_and_b32 v6, 7, v1
    v_lshlrev_b32 v6, 15, v6
    v_lshrrev_b32 v5, 3, v1
    v_lshl_add_u32 v6, v5, 2, v6
    s_lshl_b32 s62, s65, 1
    s_and_b32 s3, s66, 1
    s_add_u32 s62, s62, s3
    s_lshl_b32 s62, s62, 8
    s_lshl_b32 s3, s4, 5
    s_add_u32 s62, s62, s3
    s_lshr_b32 s3, s66, 1
    s_xor_b32 s3, s3, 1
    s_lshl_b32 s3, s3, 18
    s_add_u32 s62, s62, s3
    s_add_u32 s62, s62, 0x400000
    s_add_u32 s3, s62, 0
    buffer_load_dword v32, v6, s[40:43], s3 offen sc1
    s_add_u32 s3, s62, 8192
    buffer_load_dword v33, v6, s[40:43], s3 offen sc1
    s_add_u32 s3, s62, 16384
    buffer_load_dword v34, v6, s[40:43], s3 offen sc1
    s_add_u32 s3, s62, 24576
    buffer_load_dword v35, v6, s[40:43], s3 offen sc1
L_c_rs:
    s_or_b32 s3, s2, s4
    s_cmp_lg_u32 s3, 0
    s_cbranch_scc1 L_c_noep
    v_mov_b32 v3, 0
    v_mov_b32 v4, s5
    s_mov_b64 exec, 1
    buffer_store_dword v4, v3, s[40:43], 0 offen offset:0 sc1
    s_mov_b64 exec, -1
L_c_noep:
    v_lshrrev_b32 v3, 3, v1
    s_and_b32 s3, s4, 3
    v_lshl_add_u32 v3, s3, 3, v3
    v_bfe_u32 v4, v1, 1, 1
    v_lshl_add_u32 v2, v4, 5, v3
    v_lshlrev_b32 v2, 4, v2
    v_and_b32 v4, 7, v1
    v_lshlrev_b32 v5, 5, v4
    v_xor_b32 v2, v2, v5
    v_bfe_u32 v5, v1, 2, 1
    v_lshl_add_u32 v2, v5, 15, v2
    v_and_b32 v5, 1, v1
    v_lshl_add_u32 v2, v5, 13, v2
    s_lshr_b32 s57, s4, 2
    s_lshl_b32 s3, s57, 14
    s_add_u32 s3, s3, 94208
    v_add_u32 v2, s3, v2
    s_lshl_b32 s3, s57, 7
    s_add_u32 s3, s3, 161792
    v_lshl_add_u32 v8, v3, 2, s3
    v_lshrrev_b32 v9, 2, v3
    v_lshlrev_b32 v9, 13, v9
    v_and_b32 v5, 3, v3
    v_lshl_add_u32 v9, v5, 10, v9
    v_lshl_add_u32 v9, v4, 4, v9
    s_lshl_b32 s58, s65, 1
    s_and_b32 s3, s66, 1
    s_add_u32 s58, s58, s3
    s_lshl_b32 s58, s58, 16
    s_lshl_b32 s3, s57, 12
    s_add_u32 s58, s58, s3
    s_lshr_b32 s3, s66, 1
    s_xor_b32 s3, s3, 1
    s_lshl_b32 s3, s3, 7
    s_add_u32 s58, s58, s3
    s_waitcnt vmcnt(0)
    v_lshlrev_b32 v40, 16, v32
    v_and_b32 v41, s59, v32
    v_lshlrev_b32 v42, 16, v33
    v_and_b32 v43, s59, v33
    v_lshlrev_b32 v44, 16, v34
    v_and_b32 v45, s59, v34
    v_lshlrev_b32 v46, 16, v35
    v_and_b32 v47, s59, v35
    s_mov_b32 s44, s34
    s_and_b32 s45, s35, 0xffff
    s_mov_b32 s46, 0x200000
    s_mov_b32 s47, 0x20000
    s_waitcnt lgkmcnt(0)
    s_barrier
    ds_read_b32 v12, v8
    ds_read_b128 v[128:131], v2 offset:0
    ds_read_b128 v[132:135], v2 offset:1024
    ds_read_b128 v[136:139], v2 offset:2048
    ds_read_b128 v[140:143], v2 offset:3072
    ds_read_b128 v[144:147], v2 offset:4096
    ds_read_b128 v[148:151], v2 offset:5120
    ds_read_b128 v[152:155], v2 offset:6144
    ds_read_b128 v[156:159], v2 offset:7168
    s_waitcnt lgkmcnt(4)
    v_pk_add_f32 v[128:129], v[128:129], v[136:137]
    v_pk_add_f32 v[130:131], v[130:131], v[138:139]
    v_pk_add_f32 v[132:133], v[132:133], v[140:141]
    v_pk_add_f32 v[134:135], v[134:135], v[142:143]
    s_waitcnt lgkmcnt(2)
    v_pk_add_f32 v[128:129], v[128:129], v[144:145]
    v_pk_add_f32 v[130:131], v[130:131], v[146:147]
    v_pk_add_f32 v[132:133], v[132:133], v[148:149]
    v_pk_add_f32 v[134:135], v[134:135], v[150:151]
    s_waitcnt lgkmcnt(0)
    v_pk_add_f32 v[128:129], v[128:129], v[152:153]
    v_pk_add_f32 v[130:131], v[130:131], v[154:155]
    v_pk_add_f32 v[132:133], v[132:133], v[156:157]
    v_pk_add_f32 v[134:135], v[134:135], v[158:159]
    v_pk_fma_f32 v[128:129], v[128:129], v[12:13], v[40:41] op_sel_hi:[1,0,1]
    v_pk_fma_f32 v[130:131], v[130:131], v[12:13], v[42:43] op_sel_hi:[1,0,1]
    v_pk_fma_f32 v[132:133], v[132:133], v[12:13], v[44:45] op_sel_hi:[1,0,1]
    v_pk_fma_f32 v[134:135], v[134:135], v[12:13], v[46:47] op_sel_hi:[1,0,1]
    v_cvt_pk_bf16_f32 v16, v128, v129
    v_cvt_pk_bf16_f32 v17, v130, v131
    v_cvt_pk_bf16_f32 v18, v132, v133
    v_cvt_pk_bf16_f32 v19, v134, v135
    buffer_store_dwordx4 v[16:19], v9, s[44:47], s58 offen sc1
    s_endpgm
L_h:
    v_lshlrev_b32 v7, 4, v1
    s_mov_b32 s0, 0
    s_and_b32 s65, s2, 3
    s_lshl_b32 s65, s65, 2
    s_bfe_u32 s3, s2, 0x20003
    s_add_u32 s65, s65, s3
    s_and_b32 s66, s2, 4
    s_lshl_b32 s66, s66, 1
    s_lshr_b32 s3, s2, 5
    s_add_u32 s66, s66, s3
    s_sub_u32 s56, s4, 4
    v_lshlrev_b32 v7, 4, v1
    v_lshrrev_b32 v2, 3, v1
    v_and_b32 v3, 7, v1
    v_and_b32 v4, 2, v2
    v_lshlrev_b32 v5, 1, v4
    v_xor_b32 v5, v3, v5
    v_lshlrev_b32 v10, 10, v2
    v_lshl_add_u32 v10, v5, 4, v10
    s_lshr_b32 s60, s66, 1
    s_xor_b32 s60, s60, 1
    s_lshl_b32 s60, s60, 7
    s_mul_i32 s61, s56, 196608
    s_add_u32 s61, s61, 1048576
    s_add_u32 s61, s61, s60
    s_lshl_b32 s3, s56, 18
    s_add_u32 s60, s60, s3
    s_and_b32 s57, s56, 1
    s_lshl_b32 s57, s57, 2
    v_xor_b32 v3, v3, v4
    v_xor_b32 v3, s57, v3
    s_and_b32 s57, s56, 2
    v_mul_u32_u24 v13, 3584, v2
    v_lshl_add_u32 v13, v3, 4, v13
    s_and_b32 s62, s56, 1
    s_mul_i32 s62, s62, 28672
    s_lshl_b32 s3, s66, 7
    s_add_u32 s62, s62, s3
    s_lshl_b32 s63, s56, 10
    s_lshl_b32 s58, s2, 2
    s_add_u32 s58, s58, s56
    s_mul_i32 s59, s58, 1792
    s_waitcnt lgkmcnt(0)
    s_load_dword s5, s[38:39], 0
    s_mov_b32 s52, s32
    s_and_b32 s53, s33, 0xffff
    s_mov_b32 s54, 0x1c0000
    s_mov_b32 s55, 0x20000
    s_mov_b32 s40, s38
    s_and_b32 s41, s39, 0xffff
    s_mov_b32 s42, 0xe80000
    s_mov_b32 s43, 0x20000
    s_cmp_lg_u32 s57, 0
    s_cselect_b32 s48, s30, s28
    s_cselect_b32 s49, s31, s29
    s_and_b32 s49, s49, 0xffff
    s_mov_b32 s50, 0x1c0000
    s_mov_b32 s51, 0x20000
    s_mul_i32 s47, s2, 7
    s_lshl_b32 s3, s56, 1
    s_min_u32 s3, s3, 5
    s_add_u32 s47, s47, s3
    s_lshl_b32 s47, s47, 10
    buffer_load_dwordx4 v[16:19], v7, s[52:55], s47 offen offset:0
    buffer_load_dwordx4 v[20:23], v7, s[52:55], s47 offen offset:1024
    s_lshl_b32 s59, s56, 11
    v_bfe_u32 v2, v1, 2, 2
    v_lshrrev_b32 v3, 5, v1
    v_lshl_add_u32 v3, v3, 3, v2
    v_lshlrev_b32 v11, 7, v3
    v_lshrrev_b32 v2, 1, v2
    v_lshl_add_u32 v11, v2, 6, v11
    v_bfe_u32 v2, v1, 4, 1
    v_lshl_add_u32 v11, v2, 4, v11
    v_bfe_u32 v2, v1, 1, 1
    v_lshl_add_u32 v11, v2, 3, v11
    v_and_b32 v2, 1, v1
    v_lshl_add_u32 v11, v2, 5, v11
    s_lshl_b32 s3, s56, 11
    v_add_u32 v11, s3, v11
    v_xor_b32 v12, 64, v11
    v_add_u32 v15, s3, v7
    v_lshrrev_b32 v3, 5, v1
    v_mul_u32_u24 v3, 3072, v3
    v_add_u32 v8, v11, v3
    v_subrev_u32 v8, s63, v8
    v_xor_b32 v9, 64, v8
    v_bfe_u32 v2, v1, 3, 1
    v_bfe_u32 v3, v1, 4, 1
    v_lshl_add_u32 v2, v2, 1, v3
    v_lshrrev_b32 v3, 5, v1
    v_lshl_add_u32 v2, v3, 2, v2
    v_lshlrev_b32 v14, 13, v2
    v_and_b32 v2, 4, v2
    v_and_b32 v3, 7, v1
    v_xor_b32 v3, v3, v2
    v_lshl_add_u32 v14, v3, 4, v14
    s_lshl_b32 s64, s65, 2
    s_add_u32 s64, s64, s56
    s_lshl_b32 s64, s64, 7
    s_add_u32 s64, s64, 0x400000
    s_lshl_b32 s67, s56, 12
    s_add_u32 s67, s67, 77824
    s_waitcnt lgkmcnt(0)
    s_mul_i32 s5, s5, 0x9e3779b1
    s_add_u32 s5, s5, 0x7f4a7c15
    s_mov_b32 s0, 0
    s_bfe_u32 s3, s4, 0x10001
    s_mul_i32 s3, s3, 33792
    s_and_b32 s6, s4, 1
    s_lshl_b32 s6, s6, 8
    s_add_u32 m0, s3, s6
    s_waitcnt vmcnt(2)
    s_mov_b32 s44, 0x3fb8aa3b
    s_mov_b32 s45, 0x32a57060
    s_mov_b32 s46, 0x3f317218
    v_mul_f32 v31, s44, v24
    v_fma_f32 v32, v24, s44, -v31
    v_fma_f32 v32, v24, s45, v32
    v_exp_f32 v31, v31
    v_mul_f32 v32, s46, v32
    v_fma_f32 v31, v31, v32, v31
    v_cvt_pk_bf16_f32 v31, v31, v31
    v_lshlrev_b32 v31, 16, v31
    v_mul_f32 v25, v31, v25
    v_mul_f32 v26, v31, v26
    v_mul_f32 v25, s44, v25
    v_mul_f32 v26, 0.15915494, v26
    v_mul_f32 v36, 0x41000000, v25
    v_mul_f32 v32, 0x41000000, v26
    v_mul_f32 v37, 0x42800000, v25
    v_mul_f32 v42, 0x42800000, v26
    v_exp_f32 v36, v36
    v_fract_f32 v32, v32
    v_exp_f32 v37, v37
    v_fract_f32 v42, v42
    v_sin_f32 v33, v32
    v_cos_f32 v32, v32
    v_sin_f32 v43, v42
    v_cos_f32 v42, v42
    v_mul_f32 v33, v33, v36
    v_mul_f32 v32, v32, v36
    v_mul_f32 v43, v43, v37
    v_mul_f32 v42, v42, v37
    v_mov_b32 v40, 1.0
    v_mov_b32 v41, 0
    v_pk_mul_f32 v[44:45], v[42:43], v[42:43] op_sel:[0,0] op_sel_hi:[0,1]
    v_pk_fma_f32 v[44:45], v[42:43], v[42:43], v[44:45] op_sel:[1,1,0] op_sel_hi:[1,0,1] neg_lo:[1,0,0]
    v_pk_mul_f32 v[46:47], v[44:45], v[42:43] op_sel:[0,0] op_sel_hi:[0,1]
    v_pk_fma_f32 v[46:47], v[44:45], v[42:43], v[46:47] op_sel:[1,1,0] op_sel_hi:[1,0,1] neg_lo:[1,0,0]
    v_pk_mul_f32 v[48:49], v[40:41], v[32:33] op_sel:[0,0] op_sel_hi:[0,1]
    v_pk_mul_f32 v[50:51], v[42:43], v[32:33] op_sel:[0,0] op_sel_hi:[0,1]
    v_pk_mul_f32 v[52:53], v[44:45], v[32:33] op_sel:[0,0] op_sel_hi:[0,1]
    v_pk_mul_f32 v[54:55], v[46:47], v[32:33] op_sel:[0,0] op_sel_hi:[0,1]
    v_pk_fma_f32 v[48:49], v[40:41], v[32:33], v[48:49] op_sel:[1,1,0] op_sel_hi:[1,0,1] neg_lo:[1,0,0]
    v_pk_fma_f32 v[50:51], v[42:43], v[32:33], v[50:51] op_sel:[1,1,0] op_sel_hi:[1,0,1] neg_lo:[1,0,0]
    v_pk_fma_f32 v[52:53], v[44:45], v[32:33], v[52:53] op_sel:[1,1,0] op_sel_hi:[1,0,1] neg_lo:[1,0,0]
    v_pk_fma_f32 v[54:55], v[46:47], v[32:33], v[54:55] op_sel:[1,1,0] op_sel_hi:[1,0,1] neg_lo:[1,0,0]
    v_cvt_pk_bf16_f32 v56, v40, v41
    v_cvt_pk_bf16_f32 v57, v42, v43
    v_cvt_pk_bf16_f32 v58, v44, v45
    v_cvt_pk_bf16_f32 v59, v46, v47
    ds_write_addtid_b32 v56 offset:16896
    ds_write_addtid_b32 v57 offset:21120
    ds_write_addtid_b32 v58 offset:25344
    ds_write_addtid_b32 v59 offset:29568
    v_pk_mul_f32 v[40:41], v[48:49], v[32:33] op_sel:[0,0] op_sel_hi:[0,1]
    v_pk_mul_f32 v[42:43], v[50:51], v[32:33] op_sel:[0,0] op_sel_hi:[0,1]
    v_pk_mul_f32 v[44:45], v[52:53], v[32:33] op_sel:[0,0] op_sel_hi:[0,1]
    v_pk_mul_f32 v[46:47], v[54:55], v[32:33] op_sel:[0,0] op_sel_hi:[0,1]
    v_pk_fma_f32 v[40:41], v[48:49], v[32:33], v[40:41] op_sel:[1,1,0] op_sel_hi:[1,0,1] neg_lo:[1,0,0]
    v_pk_fma_f32 v[42:43], v[50:51], v[32:33], v[42:43] op_sel:[1,1,0] op_sel_hi:[1,0,1] neg_lo:[1,0,0]
    v_pk_fma_f32 v[44:45], v[52:53], v[32:33], v[44:45] op_sel:[1,1,0] op_sel_hi:[1,0,1] neg_lo:[1,0,0]
    v_pk_fma_f32 v[46:47], v[54:55], v[32:33], v[46:47] op_sel:[1,1,0] op_sel_hi:[1,0,1] neg_lo:[1,0,0]
    v_cvt_pk_bf16_f32 v60, v48, v49
    v_cvt_pk_bf16_f32 v61, v50, v51
    v_cvt_pk_bf16_f32 v62, v52, v53
    v_cvt_pk_bf16_f32 v63, v54, v55
    ds_write_addtid_b32 v60 offset:17424
    ds_write_addtid_b32 v61 offset:21648
    ds_write_addtid_b32 v62 offset:25872
    ds_write_addtid_b32 v63 offset:30096
    v_pk_mul_f32 v[48:49], v[40:41], v[32:33] op_sel:[0,0] op_sel_hi:[0,1]
    v_pk_mul_f32 v[50:51], v[42:43], v[32:33] op_sel:[0,0] op_sel_hi:[0,1]
    v_pk_mul_f32 v[52:53], v[44:45], v[32:33] op_sel:[0,0] op_sel_hi:[0,1]
    v_pk_mul_f32 v[54:55], v[46:47], v[32:33] op_sel:[0,0] op_sel_hi:[0,1]
    v_pk_fma_f32 v[48:49], v[40:41], v[32:33], v[48:49] op_sel:[1,1,0] op_sel_hi:[1,0,1] neg_lo:[1,0,0]
    v_pk_fma_f32 v[50:51], v[42:43], v[32:33], v[50:51] op_sel:[1,1,0] op_sel_hi:[1,0,1] neg_lo:[1,0,0]
    v_pk_fma_f32 v[52:53], v[44:45], v[32:33], v[52:53] op_sel:[1,1,0] op_sel_hi:[1,0,1] neg_lo:[1,0,0]
    v_pk_fma_f32 v[54:55], v[46:47], v[32:33], v[54:55] op_sel:[1,1,0] op_sel_hi:[1,0,1] neg_lo:[1,0,0]
    v_cvt_pk_bf16_f32 v56, v40, v41
    v_cvt_pk_bf16_f32 v57, v42, v43
    v_cvt_pk_bf16_f32 v58, v44, v45
    v_cvt_pk_bf16_f32 v59, v46, v47
    ds_write_addtid_b32 v56 offset:17952
    ds_write_addtid_b32 v57 offset:22176
    ds_write_addtid_b32 v58 offset:26400
    ds_write_addtid_b32 v59 offset:30624
    v_pk_mul_f32 v[40:41], v[48:49], v[32:33] op_sel:[0,0] op_sel_hi:[0,1]
    v_pk_mul_f32 v[42:43], v[50:51], v[32:33] op_sel:[0,0] op_sel_hi:[0,1]
    v_pk_mul_f32 v[44:45], v[52:53], v[32:33] op_sel:[0,0] op_sel_hi:[0,1]
    v_pk_mul_f32 v[46:47], v[54:55], v[32:33] op_sel:[0,0] op_sel_hi:[0,1]
    v_pk_fma_f32 v[40:41], v[48:49], v[32:33], v[40:41] op_sel:[1,1,0] op_sel_hi:[1,0,1] neg_lo:[1,0,0]
    v_pk_fma_f32 v[42:43], v[50:51], v[32:33], v[42:43] op_sel:[1,1,0] op_sel_hi:[1,0,1] neg_lo:[1,0,0]
    v_pk_fma_f32 v[44:45], v[52:53], v[32:33], v[44:45] op_sel:[1,1,0] op_sel_hi:[1,0,1] neg_lo:[1,0,0]
    v_pk_fma_f32 v[46:47], v[54:55], v[32:33], v[46:47] op_sel:[1,1,0] op_sel_hi:[1,0,1] neg_lo:[1,0,0]
    v_cvt_pk_bf16_f32 v60, v48, v49
    v_cvt_pk_bf16_f32 v61, v50, v51
    v_cvt_pk_bf16_f32 v62, v52, v53
    v_cvt_pk_bf16_f32 v63, v54, v55
    ds_write_addtid_b32 v60 offset:18480
    ds_write_addtid_b32 v61 offset:22704
    ds_write_addtid_b32 v62 offset:26928
    ds_write_addtid_b32 v63 offset:31152
    v_pk_mul_f32 v[48:49], v[40:41], v[32:33] op_sel:[0,0] op_sel_hi:[0,1]
    v_pk_mul_f32 v[50:51], v[42:43], v[32:33] op_sel:[0,0] op_sel_hi:[0,1]
    v_pk_mul_f32 v[52:53], v[44:45], v[32:33] op_sel:[0,0] op_sel_hi:[0,1]
    v_pk_mul_f32 v[54:55], v[46:47], v[32:33] op_sel:[0,0] op_sel_hi:[0,1]
    v_pk_fma_f32 v[48:49], v[40:41], v[32:33], v[48:49] op_sel:[1,1,0] op_sel_hi:[1,0,1] neg_lo:[1,0,0]
    v_pk_fma_f32 v[50:51], v[42:43], v[32:33], v[50:51] op_sel:[1,1,0] op_sel_hi:[1,0,1] neg_lo:[1,0,0]
    v_pk_fma_f32 v[52:53], v[44:45], v[32:33], v[52:53] op_sel:[1,1,0] op_sel_hi:[1,0,1] neg_lo:[1,0,0]
    v_pk_fma_f32 v[54:55], v[46:47], v[32:33], v[54:55] op_sel:[1,1,0] op_sel_hi:[1,0,1] neg_lo:[1,0,0]
    v_cvt_pk_bf16_f32 v56, v40, v41
    v_cvt_pk_bf16_f32 v57, v42, v43
    v_cvt_pk_bf16_f32 v58, v44, v45
    v_cvt_pk_bf16_f32 v59, v46, v47
    ds_write_addtid_b32 v56 offset:19008
    ds_write_addtid_b32 v57 offset:23232
    ds_write_addtid_b32 v58 offset:27456
    ds_write_addtid_b32 v59 offset:31680
    v_pk_mul_f32 v[40:41], v[48:49], v[32:33] op_sel:[0,0] op_sel_hi:[0,1]
    v_pk_mul_f32 v[42:43], v[50:51], v[32:33] op_sel:[0,0] op_sel_hi:[0,1]
    v_pk_mul_f32 v[44:45], v[52:53], v[32:33] op_sel:[0,0] op_sel_hi:[0,1]
    v_pk_mul_f32 v[46:47], v[54:55], v[32:33] op_sel:[0,0] op_sel_hi:[0,1]
    v_pk_fma_f32 v[40:41], v[48:49], v[32:33], v[40:41] op_sel:[1,1,0] op_sel_hi:[1,0,1] neg_lo:[1,0,0]
    v_pk_fma_f32 v[42:43], v[50:51], v[32:33], v[42:43] op_sel:[1,1,0] op_sel_hi:[1,0,1] neg_lo:[1,0,0]
    v_pk_fma_f32 v[44:45], v[52:53], v[32:33], v[44:45] op_sel:[1,1,0] op_sel_hi:[1,0,1] neg_lo:[1,0,0]
    v_pk_fma_f32 v[46:47], v[54:55], v[32:33], v[46:47] op_sel:[1,1,0] op_sel_hi:[1,0,1] neg_lo:[1,0,0]
    v_cvt_pk_bf16_f32 v60, v48, v49
    v_cvt_pk_bf16_f32 v61, v50, v51
    v_cvt_pk_bf16_f32 v62, v52, v53
    v_cvt_pk_bf16_f32 v63, v54, v55
    ds_write_addtid_b32 v60 offset:19536
    ds_write_addtid_b32 v61 offset:23760
    ds_write_addtid_b32 v62 offset:27984
    ds_write_addtid_b32 v63 offset:32208
    v_pk_mul_f32 v[48:49], v[40:41], v[32:33] op_sel:[0,0] op_sel_hi:[0,1]
    v_pk_mul_f32 v[50:51], v[42:43], v[32:33] op_sel:[0,0] op_sel_hi:[0,1]
    v_pk_mul_f32 v[52:53], v[44:45], v[32:33] op_sel:[0,0] op_sel_hi:[0,1]
    v_pk_mul_f32 v[54:55], v[46:47], v[32:33] op_sel:[0,0] op_sel_hi:[0,1]
    v_pk_fma_f32 v[48:49], v[40:41], v[32:33], v[48:49] op_sel:[1,1,0] op_sel_hi:[1,0,1] neg_lo:[1,0,0]
    v_pk_fma_f32 v[50:51], v[42:43], v[32:33], v[50:51] op_sel:[1,1,0] op_sel_hi:[1,0,1] neg_lo:[1,0,0]
    v_pk_fma_f32 v[52:53], v[44:45], v[32:33], v[52:53] op_sel:[1,1,0] op_sel_hi:[1,0,1] neg_lo:[1,0,0]
    v_pk_fma_f32 v[54:55], v[46:47], v[32:33], v[54:55] op_sel:[1,1,0] op_sel_hi:[1,0,1] neg_lo:[1,0,0]
    v_cvt_pk_bf16_f32 v56, v40, v41
    v_cvt_pk_bf16_f32 v57, v42, v43
    v_cvt_pk_bf16_f32 v58, v44, v45
    v_cvt_pk_bf16_f32 v59, v46, v47
    ds_write_addtid_b32 v56 offset:20064
    ds_write_addtid_b32 v57 offset:24288
    ds_write_addtid_b32 v58 offset:28512
    ds_write_addtid_b32 v59 offset:32736
    v_cvt_pk_bf16_f32 v60, v48, v49
    v_cvt_pk_bf16_f32 v61, v50, v51
    v_cvt_pk_bf16_f32 v62, v52, v53
    v_cvt_pk_bf16_f32 v63, v54, v55
    ds_write_addtid_b32 v60 offset:20592
    ds_write_addtid_b32 v61 offset:24816
    ds_write_addtid_b32 v62 offset:29040
    ds_write_addtid_b32 v63 offset:33264
    v_mul_f32 v36, 0x3f800000, v25
    v_mul_f32 v32, 0x3f800000, v26
    v_mul_f32 v37, 0x43800000, v25
    v_mul_f32 v34, 0x43800000, v26
    v_exp_f32 v36, v36
    v_fract_f32 v32, v32
    v_exp_f32 v37, v37
    v_fract_f32 v34, v34
    v_sin_f32 v33, v32
    v_cos_f32 v32, v32
    v_sin_f32 v35, v34
    v_cos_f32 v34, v34
    v_mul_f32 v33, v33, v36
    v_mul_f32 v32, v32, v36
    v_mul_f32 v35, v35, v37
    v_mul_f32 v34, v34, v37
    v_mul_f32 v38, v31, v27
    v_mul_f32 v39, v31, v28
    v_mov_b32 v28, v29
    v_mov_b32 v29, v30
    v_pk_mul_f32 v[40:41], v[28:29], v[38:39] op_sel:[0,0] op_sel_hi:[0,1]
    v_pk_mul_f32 v[72:73], v[32:33], v[32:33] op_sel:[0,0] op_sel_hi:[0,1]
    v_pk_mul_f32 v[60:61], v[34:35], v[34:35] op_sel:[0,0] op_sel_hi:[0,1]
    v_pk_fma_f32 v[40:41], v[28:29], v[38:39], v[40:41] op_sel:[1,1,0] op_sel_hi:[1,0,1] neg_lo:[1,0,0]
    v_pk_fma_f32 v[72:73], v[32:33], v[32:33], v[72:73] op_sel:[1,1,0] op_sel_hi:[1,0,1] neg_lo:[1,0,0]
    v_pk_fma_f32 v[60:61], v[34:35], v[34:35], v[60:61] op_sel:[1,1,0] op_sel_hi:[1,0,1] neg_lo:[1,0,0]
    v_pk_mul_f32 v[42:43], v[40:41], v[32:33] op_sel:[0,0] op_sel_hi:[0,1]
    v_pk_mul_f32 v[44:45], v[40:41], v[72:73] op_sel:[0,0] op_sel_hi:[0,1]
    v_pk_mul_f32 v[74:75], v[72:73], v[72:73] op_sel:[0,0] op_sel_hi:[0,1]
    v_pk_mul_f32 v[62:63], v[60:61], v[34:35] op_sel:[0,0] op_sel_hi:[0,1]
    v_pk_mul_f32 v[64:65], v[60:61], v[60:61] op_sel:[0,0] op_sel_hi:[0,1]
    v_pk_fma_f32 v[42:43], v[40:41], v[32:33], v[42:43] op_sel:[1,1,0] op_sel_hi:[1,0,1] neg_lo:[1,0,0]
    v_pk_fma_f32 v[44:45], v[40:41], v[72:73], v[44:45] op_sel:[1,1,0] op_sel_hi:[1,0,1] neg_lo:[1,0,0]
    v_pk_fma_f32 v[74:75], v[72:73], v[72:73], v[74:75] op_sel:[1,1,0] op_sel_hi:[1,0,1] neg_lo:[1,0,0]
    v_pk_fma_f32 v[62:63], v[60:61], v[34:35], v[62:63] op_sel:[1,1,0] op_sel_hi:[1,0,1] neg_lo:[1,0,0]
    v_pk_fma_f32 v[64:65], v[60:61], v[60:61], v[64:65] op_sel:[1,1,0] op_sel_hi:[1,0,1] neg_lo:[1,0,0]
    v_pk_mul_f32 v[46:47], v[42:43], v[72:73] op_sel:[0,0] op_sel_hi:[0,1]
    v_pk_mul_f32 v[48:49], v[40:41], v[74:75] op_sel:[0,0] op_sel_hi:[0,1]
    v_pk_mul_f32 v[50:51], v[42:43], v[74:75] op_sel:[0,0] op_sel_hi:[0,1]
    v_pk_mul_f32 v[52:53], v[44:45], v[74:75] op_sel:[0,0] op_sel_hi:[0,1]
    v_pk_mul_f32 v[66:67], v[64:65], v[34:35] op_sel:[0,0] op_sel_hi:[0,1]
    v_pk_mul_f32 v[68:69], v[62:63], v[62:63] op_sel:[0,0] op_sel_hi:[0,1]
    v_pk_mul_f32 v[70:71], v[64:65], v[62:63] op_sel:[0,0] op_sel_hi:[0,1]
    v_pk_fma_f32 v[46:47], v[42:43], v[72:73], v[46:47] op_sel:[1,1,0] op_sel_hi:[1,0,1] neg_lo:[1,0,0]
    v_pk_fma_f32 v[48:49], v[40:41], v[74:75], v[48:49] op_sel:[1,1,0] op_sel_hi:[1,0,1] neg_lo:[1,0,0]
    v_pk_fma_f32 v[50:51], v[42:43], v[74:75], v[50:51] op_sel:[1,1,0] op_sel_hi:[1,0,1] neg_lo:[1,0,0]
    v_pk_fma_f32 v[52:53], v[44:45], v[74:75], v[52:53] op_sel:[1,1,0] op_sel_hi:[1,0,1] neg_lo:[1,0,0]
    v_pk_fma_f32 v[66:67], v[64:65], v[34:35], v[66:67] op_sel:[1,1,0] op_sel_hi:[1,0,1] neg_lo:[1,0,0]
    v_pk_fma_f32 v[68:69], v[62:63], v[62:63], v[68:69] op_sel:[1,1,0] op_sel_hi:[1,0,1] neg_lo:[1,0,0]
    v_pk_fma_f32 v[70:71], v[64:65], v[62:63], v[70:71] op_sel:[1,1,0] op_sel_hi:[1,0,1] neg_lo:[1,0,0]
    v_pk_mul_f32 v[54:55], v[46:47], v[74:75] op_sel:[0,0] op_sel_hi:[0,1]
    v_pk_mul_f32 v[56:57], v[48:49], v[74:75] op_sel:[0,0] op_sel_hi:[0,1]
    v_pk_fma_f32 v[54:55], v[46:47], v[74:75], v[54:55] op_sel:[1,1,0] op_sel_hi:[1,0,1] neg_lo:[1,0,0]
    v_pk_fma_f32 v[56:57], v[48:49], v[74:75], v[56:57] op_sel:[1,1,0] op_sel_hi:[1,0,1] neg_lo:[1,0,0]
    v_cvt_pk_bf16_f32 v92, v40, -v41
    v_cvt_pk_bf16_f32 v93, v42, -v43
    v_cvt_pk_bf16_f32 v94, v44, -v45
    v_cvt_pk_bf16_f32 v95, v46, -v47
    v_cvt_pk_bf16_f32 v96, v48, -v49
    v_cvt_pk_bf16_f32 v97, v50, -v51
    v_cvt_pk_bf16_f32 v98, v52, -v53
    v_cvt_pk_bf16_f32 v99, v54, -v55
    v_cvt_pk_bf16_f32 v100, v56, -v57
    ds_write_addtid_b32 v92 offset:0
    ds_write_addtid_b32 v93 offset:528
    ds_write_addtid_b32 v94 offset:1056
    ds_write_addtid_b32 v95 offset:1584
    ds_write_addtid_b32 v96 offset:4224
    ds_write_addtid_b32 v97 offset:4752
    ds_write_addtid_b32 v98 offset:5280
    ds_write_addtid_b32 v99 offset:5808
    ds_write_addtid_b32 v100 offset:8448
    v_pk_mul_f32 v[76:77], v[40:41], v[34:35] op_sel:[0,0] op_sel_hi:[0,1]
    v_pk_mul_f32 v[78:79], v[44:45], v[34:35] op_sel:[0,0] op_sel_hi:[0,1]
    v_pk_mul_f32 v[80:81], v[48:49], v[34:35] op_sel:[0,0] op_sel_hi:[0,1]
    v_pk_mul_f32 v[82:83], v[52:53], v[34:35] op_sel:[0,0] op_sel_hi:[0,1]
    v_pk_mul_f32 v[84:85], v[56:57], v[34:35] op_sel:[0,0] op_sel_hi:[0,1]
    v_pk_mul_f32 v[86:87], v[40:41], v[60:61] op_sel:[0,0] op_sel_hi:[0,1]
    v_pk_mul_f32 v[88:89], v[48:49], v[60:61] op_sel:[0,0] op_sel_hi:[0,1]
    v_pk_fma_f32 v[76:77], v[40:41], v[34:35], v[76:77] op_sel:[1,1,0] op_sel_hi:[1,0,1] neg_lo:[1,0,0]
    v_pk_fma_f32 v[78:79], v[44:45], v[34:35], v[78:79] op_sel:[1,1,0] op_sel_hi:[1,0,1] neg_lo:[1,0,0]
    v_pk_fma_f32 v[80:81], v[48:49], v[34:35], v[80:81] op_sel:[1,1,0] op_sel_hi:[1,0,1] neg_lo:[1,0,0]
    v_pk_fma_f32 v[82:83], v[52:53], v[34:35], v[82:83] op_sel:[1,1,0] op_sel_hi:[1,0,1] neg_lo:[1,0,0]
    v_pk_fma_f32 v[84:85], v[56:57], v[34:35], v[84:85] op_sel:[1,1,0] op_sel_hi:[1,0,1] neg_lo:[1,0,0]
    v_pk_fma_f32 v[86:87], v[40:41], v[60:61], v[86:87] op_sel:[1,1,0] op_sel_hi:[1,0,1] neg_lo:[1,0,0]
    v_pk_fma_f32 v[88:89], v[48:49], v[60:61], v[88:89] op_sel:[1,1,0] op_sel_hi:[1,0,1] neg_lo:[1,0,0]
    v_cvt_pk_bf16_f32 v102, v76, -v77
    v_cvt_pk_bf16_f32 v103, v78, -v79
    v_cvt_pk_bf16_f32 v104, v80, -v81
    v_cvt_pk_bf16_f32 v105, v82, -v83
    v_cvt_pk_bf16_f32 v106, v84, -v85
    v_cvt_pk_bf16_f32 v107, v86, -v87
    v_cvt_pk_bf16_f32 v108, v88, -v89
    ds_write_addtid_b32 v102 offset:2112
    ds_write_addtid_b32 v102 offset:2640
    ds_write_addtid_b32 v103 offset:3168
    ds_write_addtid_b32 v104 offset:3696
    ds_write_addtid_b32 v104 offset:6336
    ds_write_addtid_b32 v104 offset:6864
    ds_write_addtid_b32 v105 offset:7392
    ds_write_addtid_b32 v106 offset:7920
    ds_write_addtid_b32 v106 offset:10560
    ds_write_addtid_b32 v107 offset:8976
    ds_write_addtid_b32 v108 offset:9504
    v_pk_mul_f32 v[76:77], v[56:57], v[60:61] op_sel:[0,0] op_sel_hi:[0,1]
    v_pk_mul_f32 v[78:79], v[40:41], v[62:63] op_sel:[0,0] op_sel_hi:[0,1]
    v_pk_mul_f32 v[80:81], v[48:49], v[62:63] op_sel:[0,0] op_sel_hi:[0,1]
    v_pk_mul_f32 v[82:83], v[56:57], v[62:63] op_sel:[0,0] op_sel_hi:[0,1]
    v_pk_mul_f32 v[84:85], v[40:41], v[64:65] op_sel:[0,0] op_sel_hi:[0,1]
    v_pk_mul_f32 v[86:87], v[56:57], v[64:65] op_sel:[0,0] op_sel_hi:[0,1]
    v_pk_mul_f32 v[88:89], v[40:41], v[66:67] op_sel:[0,0] op_sel_hi:[0,1]
    v_pk_fma_f32 v[76:77], v[56:57], v[60:61], v[76:77] op_sel:[1,1,0] op_sel_hi:[1,0,1] neg_lo:[1,0,0]
    v_pk_fma_f32 v[78:79], v[40:41], v[62:63], v[78:79] op_sel:[1,1,0] op_sel_hi:[1,0,1] neg_lo:[1,0,0]
    v_pk_fma_f32 v[80:81], v[48:49], v[62:63], v[80:81] op_sel:[1,1,0] op_sel_hi:[1,0,1] neg_lo:[1,0,0]
    v_pk_fma_f32 v[82:83], v[56:57], v[62:63], v[82:83] op_sel:[1,1,0] op_sel_hi:[1,0,1] neg_lo:[1,0,0]
    v_pk_fma_f32 v[84:85], v[40:41], v[64:65], v[84:85] op_sel:[1,1,0] op_sel_hi:[1,0,1] neg_lo:[1,0,0]
    v_pk_fma_f32 v[86:87], v[56:57], v[64:65], v[86:87] op_sel:[1,1,0] op_sel_hi:[1,0,1] neg_lo:[1,0,0]
    v_pk_fma_f32 v[88:89], v[40:41], v[66:67], v[88:89] op_sel:[1,1,0] op_sel_hi:[1,0,1] neg_lo:[1,0,0]
    v_cvt_pk_bf16_f32 v92, v76, -v77
    v_cvt_pk_bf16_f32 v93, v78, -v79
    v_cvt_pk_bf16_f32 v94, v80, -v81
    v_cvt_pk_bf16_f32 v95, v82, -v83
    v_cvt_pk_bf16_f32 v96, v84, -v85
    v_cvt_pk_bf16_f32 v97, v86, -v87
    v_cvt_pk_bf16_f32 v98, v88, -v89
    ds_write_addtid_b32 v92 offset:10032
    ds_write_addtid_b32 v93 offset:11088
    ds_write_addtid_b32 v94 offset:11616
    ds_write_addtid_b32 v95 offset:12144
    ds_write_addtid_b32 v96 offset:12672
    ds_write_addtid_b32 v97 offset:13200
    ds_write_addtid_b32 v98 offset:14784
    v_pk_mul_f32 v[76:77], v[56:57], v[66:67] op_sel:[0,0] op_sel_hi:[0,1]
    v_pk_mul_f32 v[78:79], v[40:41], v[68:69] op_sel:[0,0] op_sel_hi:[0,1]
    v_pk_mul_f32 v[80:81], v[56:57], v[68:69] op_sel:[0,0] op_sel_hi:[0,1]
    v_pk_mul_f32 v[82:83], v[40:41], v[70:71] op_sel:[0,0] op_sel_hi:[0,1]
    v_pk_mul_f32 v[84:85], v[56:57], v[70:71] op_sel:[0,0] op_sel_hi:[0,1]
    v_pk_fma_f32 v[76:77], v[56:57], v[66:67], v[76:77] op_sel:[1,1,0] op_sel_hi:[1,0,1] neg_lo:[1,0,0]
    v_pk_fma_f32 v[78:79], v[40:41], v[68:69], v[78:79] op_sel:[1,1,0] op_sel_hi:[1,0,1] neg_lo:[1,0,0]
    v_pk_fma_f32 v[80:81], v[56:57], v[68:69], v[80:81] op_sel:[1,1,0] op_sel_hi:[1,0,1] neg_lo:[1,0,0]
    v_pk_fma_f32 v[82:83], v[40:41], v[70:71], v[82:83] op_sel:[1,1,0] op_sel_hi:[1,0,1] neg_lo:[1,0,0]
    v_pk_fma_f32 v[84:85], v[56:57], v[70:71], v[84:85] op_sel:[1,1,0] op_sel_hi:[1,0,1] neg_lo:[1,0,0]
    v_cvt_pk_bf16_f32 v102, v76, -v77
    v_cvt_pk_bf16_f32 v103, v78, -v79
    v_cvt_pk_bf16_f32 v104, v80, -v81
    v_cvt_pk_bf16_f32 v105, v82, -v83
    v_cvt_pk_bf16_f32 v106, v84, -v85
    ds_write_addtid_b32 v102 offset:15312
    ds_write_addtid_b32 v103 offset:13728
    ds_write_addtid_b32 v104 offset:14256
    ds_write_addtid_b32 v105 offset:15840
    ds_write_addtid_b32 v106 offset:16368
    v_mov_b32 v112, 0x27478
    v_mov_b32 v113, 1
    s_mov_b64 exec, 1
    ds_add_u32 v112, v113
    s_mov_b64 exec, -1
    s_and_b32 s44, s4, 1
    v_and_b32 v2, 31, v1
    v_mul_u32_u24 v4, 528, v2
    v_lshrrev_b32 v6, 5, v1
    v_lshl_add_u32 v4, v6, 4, v4
    s_mul_i32 s3, s44, 33792
    v_add_u32 v4, s3, v4
    s_bitcmp1_b32 s4, 1
    s_cselect_b32 s45, 12528, 32
    s_mov_b32 s46, 8352
    s_cselect_b32 s46, 4192, s46
    s_mul_i32 s3, s44, 16640
    s_add_u32 s3, s3, 73728
    s_add_u32 s45, s45, s3
    s_add_u32 s46, s46, s3
    v_add_u32 v124, s45, v7
    v_add_u32 v125, s46, v7
    s_branch L_evk_t
L_evk:
    s_add_u32 s0, s0, 1
    s_cmp_gt_u32 s0, 4194304
    s_cbranch_scc1 L_evk_x
L_evk_t:
    ds_read_b32 v113, v112
    s_waitcnt lgkmcnt(0)
    v_cmp_gt_u32 vcc, 4, v113
    s_cbranch_vccnz L_evk
L_evk_x:
    ds_read_b128 v[128:131], v4 offset:0
    ds_read_b128 v[132:135], v4 offset:16896
    ds_read_b128 v[136:139], v4 offset:32
    ds_read_b128 v[140:143], v4 offset:16928
    ds_read_b128 v[144:147], v4 offset:64
    ds_read_b128 v[148:151], v4 offset:16960
    ds_read_b128 v[152:155], v4 offset:96
    ds_read_b128 v[156:159], v4 offset:16992
    ds_read_b128 v[160:163], v4 offset:128
    ds_read_b128 v[164:167], v4 offset:17024
    ds_read_b128 v[168:171], v4 offset:160
    ds_read_b128 v[172:175], v4 offset:17056
    ds_read_b128 v[176:179], v4 offset:192
    ds_read_b128 v[180:183], v4 offset:17088
    v_and_b32 v30, 1, v1
    v_cmp_eq_u32 vcc, 1, v30
    s_waitcnt lgkmcnt(12)
    v_mfma_f32_32x32x16_bf16 v[96:111], v[128:131], v[132:135], 0
    ds_read_b128 v[184:187], v4 offset:224
    ds_read_b128 v[188:191], v4 offset:17120
    s_waitcnt lgkmcnt(12)
    v_mfma_f32_32x32x16_bf16 v[96:111], v[136:139], v[140:143], v[96:111]
    ds_read_b128 v[128:131], v4 offset:256
    ds_read_b128 v[132:135], v4 offset:17152
    s_waitcnt lgkmcnt(12)
    v_mfma_f32_32x32x16_bf16 v[96:111], v[144:147], v[148:151], v[96:111]
    ds_read_b128 v[136:139], v4 offset:288
    ds_read_b128 v[140:143], v4 offset:17184
    s_waitcnt lgkmcnt(12)
    v_mfma_f32_32x32x16_bf16 v[96:111], v[152:155], v[156:159], v[96:111]
    ds_read_b128 v[144:147], v4 offset:320
    ds_read_b128 v[148:151], v4 offset:17216
    s_waitcnt lgkmcnt(12)
    v_mfma_f32_32x32x16_bf16 v[96:111], v[160:163], v[164:167], v[96:111]
    ds_read_b128 v[152:155], v4 offset:352
    ds_read_b128 v[156:159], v4 offset:17248
    s_waitcnt lgkmcnt(12)
    v_mfma_f32_32x32x16_bf16 v[96:111], v[168:171], v[172:175], v[96:111]
    ds_read_b128 v[160:163], v4 offset:384
    ds_read_b128 v[164:167], v4 offset:17280
    s_waitcnt lgkmcnt(12)
    v_mfma_f32_32x32x16_bf16 v[96:111], v[176:179], v[180:183], v[96:111]
    ds_read_b128 v[168:171], v4 offset:416
    ds_read_b128 v[172:175], v4 offset:17312
    s_waitcnt lgkmcnt(12)
    v_mfma_f32_32x32x16_bf16 v[96:111], v[184:187], v[188:191], v[96:111]
    ds_read_b128 v[176:179], v4 offset:448
    ds_read_b128 v[180:183], v4 offset:17344
    s_waitcnt lgkmcnt(12)
    v_mfma_f32_32x32x16_bf16 v[96:111], v[128:131], v[132:135], v[96:111]
    ds_read_b128 v[184:187], v4 offset:480
    ds_read_b128 v[188:191], v4 offset:17376
    s_waitcnt lgkmcnt(12)
    v_mfma_f32_32x32x16_bf16 v[96:111], v[136:139], v[140:143], v[96:111]
    s_waitcnt lgkmcnt(10)
    v_mfma_f32_32x32x16_bf16 v[96:111], v[144:147], v[148:151], v[96:111]
    s_waitcnt lgkmcnt(8)
    v_mfma_f32_32x32x16_bf16 v[96:111], v[152:155], v[156:159], v[96:111]
    s_waitcnt lgkmcnt(6)
    v_mfma_f32_32x32x16_bf16 v[96:111], v[160:163], v[164:167], v[96:111]
    s_waitcnt lgkmcnt(4)
    v_mfma_f32_32x32x16_bf16 v[96:111], v[168:171], v[172:175], v[96:111]
    s_waitcnt lgkmcnt(2)
    v_mfma_f32_32x32x16_bf16 v[96:111], v[176:179], v[180:183], v[96:111]
    s_waitcnt lgkmcnt(0)
    v_mfma_f32_32x32x16_bf16 v[96:111], v[184:187], v[188:191], v[96:111]
    s_bitcmp1_b32 s4, 1
    s_cbranch_scc1 L_odd
    s_nop 9
    v_cndmask_b32 v30, v108, v109, vcc
    v_cndmask_b32 v31, v110, v111, vcc
    v_mov_b32 v48, 0
    v_cvt_pk_bf16_f32 v35, v102, v103
    v_cvt_pk_bf16_f32 v32, v96, v97
    v_cvt_pk_bf16_f32 v33, v98, v99
    v_cvt_pk_bf16_f32 v34, v100, v101
    ds_write_b128 v124, v[32:35] offset:0
    v_mov_b32 v49, v32
    v_mov_b32 v50, v33
    v_mov_b32 v51, v34
    v_mov_b32_dpp v48, v35 wave_shr:1 row_mask:0xf bank_mask:0xf
    ds_write_b128 v125, v[48:51] offset:0
    v_cvt_pk_bf16_f32 v39, v107, v107
    v_cvt_pk_bf16_f32 v36, v105, v105
    v_cvt_pk_bf16_f32 v37, v105, v106
    v_cvt_pk_bf16_f32 v38, v106, v106
    ds_write_b128 v124, v[36:39] offset:1024
    v_mov_b32_dpp v52, v35 wave_ror:1 row_mask:0xf bank_mask:0xf
    v_mov_b32 v53, v36
    v_mov_b32 v54, v37
    v_mov_b32 v55, v38
    v_mov_b32_dpp v52, v39 wave_shr:1 row_mask:0xf bank_mask:0xf
    ds_write_b128 v125, v[52:55] offset:1024
    v_cvt_pk_bf16_f32 v43, v109, v109
    v_cvt_pk_bf16_f32 v40, v108, v108
    v_cvt_pk_bf16_f32 v41, v108, v108
    v_cvt_pk_bf16_f32 v42, v30, v109
    ds_write_b128 v124, v[40:43] offset:2048
    v_mov_b32_dpp v56, v39 wave_ror:1 row_mask:0xf bank_mask:0xf
    v_mov_b32 v57, v40
    v_mov_b32 v58, v41
    v_mov_b32 v59, v42
    v_mov_b32_dpp v56, v43 wave_shr:1 row_mask:0xf bank_mask:0xf
    ds_write_b128 v125, v[56:59] offset:2048
    v_cvt_pk_bf16_f32 v47, v111, v111
    v_cvt_pk_bf16_f32 v44, v110, v110
    v_cvt_pk_bf16_f32 v45, v110, v110
    v_cvt_pk_bf16_f32 v46, v31, v111
    ds_write_b128 v124, v[44:47] offset:3072
    v_mov_b32_dpp v60, v43 wave_ror:1 row_mask:0xf bank_mask:0xf
    v_mov_b32 v61, v44
    v_mov_b32 v62, v45
    v_mov_b32 v63, v46
    v_mov_b32_dpp v60, v47 wave_shr:1 row_mask:0xf bank_mask:0xf
    ds_write_b128 v125, v[60:63] offset:3072
    s_branch L_exp_j
L_odd:
    s_nop 9
    v_cndmask_b32 v30, v108, v109, vcc
    v_cndmask_b32 v31, v110, v111, vcc
    v_cvt_pk_bf16_f32 v48, 0, v96
    v_cvt_pk_bf16_f32 v35, v103, v104
    v_cvt_pk_bf16_f32 v32, v97, v98
    v_cvt_pk_bf16_f32 v33, v99, v100
    v_cvt_pk_bf16_f32 v34, v101, v102
    ds_write_b128 v124, v[32:35] offset:0
    v_mov_b32 v49, v32
    v_mov_b32 v50, v33
    v_mov_b32 v51, v34
    v_mov_b32_dpp v48, v35 wave_shr:1 row_mask:0xf bank_mask:0xf
    ds_write_b128 v125, v[48:51] offset:0
    v_cvt_pk_bf16_f32 v39, v107, v107
    v_cvt_pk_bf16_f32 v36, v105, v105
    v_cvt_pk_bf16_f32 v37, v106, v106
    v_cvt_pk_bf16_f32 v38, v106, v107
    ds_write_b128 v124, v[36:39] offset:1024
    v_mov_b32_dpp v52, v35 wave_ror:1 row_mask:0xf bank_mask:0xf
    v_mov_b32 v53, v36
    v_mov_b32 v54, v37
    v_mov_b32 v55, v38
    v_mov_b32_dpp v52, v39 wave_shr:1 row_mask:0xf bank_mask:0xf
    ds_write_b128 v125, v[52:55] offset:1024
    v_cvt_pk_bf16_f32 v43, v109, v109
    v_cvt_pk_bf16_f32 v40, v108, v108
    v_cvt_pk_bf16_f32 v41, v108, v30
    v_cvt_pk_bf16_f32 v42, v109, v109
    ds_write_b128 v124, v[40:43] offset:2048
    v_mov_b32_dpp v56, v39 wave_ror:1 row_mask:0xf bank_mask:0xf
    v_mov_b32 v57, v40
    v_mov_b32 v58, v41
    v_mov_b32 v59, v42
    v_mov_b32_dpp v56, v43 wave_shr:1 row_mask:0xf bank_mask:0xf
    ds_write_b128 v125, v[56:59] offset:2048
    v_cvt_pk_bf16_f32 v47, v111, v111
    v_cvt_pk_bf16_f32 v44, v110, v110
    v_cvt_pk_bf16_f32 v45, v110, v31
    v_cvt_pk_bf16_f32 v46, v111, v111
    ds_write_b128 v124, v[44:47] offset:3072
    v_mov_b32_dpp v60, v43 wave_ror:1 row_mask:0xf bank_mask:0xf
    v_mov_b32 v61, v44
    v_mov_b32 v62, v45
    v_mov_b32 v63, v46
    v_mov_b32_dpp v60, v47 wave_shr:1 row_mask:0xf bank_mask:0xf
    ds_write_b128 v125, v[60:63] offset:3072
    s_mov_b64 exec, 1
    v_subrev_u32 v27, 4, v124
    ds_write_b32 v27, v48
    s_mov_b64 exec, -1
L_exp_j:
    v_add_u32 v4, 0x1c600, v11
    v_add_u32 v5, 0x1c600, v12
    s_waitcnt vmcnt(0)
    v_mov_b32 v28, -1
    v_mov_b32 v29, -1
    v_mov_b32 v30, -1
    v_mov_b32 v31, -1
    v_mov_b32 v24, s5
    v_mov_b32 v25, s5
    v_mov_b32 v26, s5
    v_mov_b32 v27, s5
    s_lshl_b32 s46, s58, 11
    s_add_u32 s46, s46, 0x400000
    s_lshl_b32 s47, s56, 8
    s_add_u32 s47, s47, s2
    s_lshl_b32 s47, s47, 4
    s_add_u32 s47, s47, 0x40000
    s_lshl_b32 s44, s65, 2
    s_add_u32 s44, s44, s56
    s_mul_i32 s44, s44, 114688
    s_add_u32 s44, s44, 0x600000
    s_mul_i32 s45, s66, 3072
    s_add_u32 s45, s45, s44
    s_add_u32 s45, s45, 65536
    s_lshl_b32 s3, s66, 12
    s_add_u32 s44, s44, s3
    v_and_b32 v2, 15, v1
    v_lshlrev_b32 v2, 3, v2
    v_bfe_u32 v3, v1, 4, 1
    v_mul_u32_u24 v3, 14336, v3
    v_add_u32 v2, v2, v3
    v_lshrrev_b32 v3, 5, v1
    v_mul_u32_u24 v3, 57344, v3
    v_add_u32 v4, v2, v3
    v_add_u32 v5, 28672, v4
    s_lshl_b32 s57, s66, 9
    s_lshl_b32 s3, s56, 7
    s_add_u32 s57, s57, s3
    s_add_u32 s57, s57, 0x20000
    s_min_u32 s3, s3, 256
    s_mul_i32 s58, s66, 384
    s_add_u32 s58, s58, s3
    s_add_u32 s58, s58, 0x22000
    v_bfe_u32 v2, v1, 3, 1
    v_lshrrev_b32 v3, 5, v1
    v_xor_b32 v2, v2, v3
    v_lshlrev_b32 v6, 14, v2
    v_lshrrev_b32 v2, 4, v1
    v_lshl_add_u32 v6, v2, 7, v6
    v_and_b32 v2, 7, v1
    v_lshl_add_u32 v6, v2, 4, v6
    s_mul_i32 s68, s66, 98304
    s_lshl_b32 s3, s56, 9
    s_add_u32 s68, s68, s3
    s_add_u32 s68, s68, 0xd00000
    s_mov_b32 s59, 0xffff0000
    s_mov_b32 s69, 0
    s_waitcnt lgkmcnt(0)
    s_barrier
    s_add_u32 m0, s63, 8192
    s_add_u32 s3, s60, 0
    buffer_load_dwordx4 v10, s[52:55], s3 offen lds
    s_add_u32 m0, s63, 12288
    s_add_u32 s3, s60, 8192
    buffer_load_dwordx4 v10, s[52:55], s3 offen lds
    s_add_u32 m0, s63, 16384
    s_add_u32 s3, s60, 16384
    buffer_load_dwordx4 v10, s[52:55], s3 offen lds
    s_add_u32 m0, s63, 20480
    s_add_u32 s3, s60, 24576
    buffer_load_dwordx4 v10, s[52:55], s3 offen lds
    s_add_u32 m0, s63, 24576
    s_add_u32 s3, s60, 32768
    buffer_load_dwordx4 v10, s[52:55], s3 offen lds
    s_add_u32 m0, s63, 28672
    s_add_u32 s3, s60, 40960
    buffer_load_dwordx4 v10, s[52:55], s3 offen lds
    s_add_u32 m0, s63, 32768
    s_add_u32 s3, s60, 49152
    buffer_load_dwordx4 v10, s[52:55], s3 offen lds
    s_add_u32 m0, s63, 36864
    s_add_u32 s3, s60, 57344
    buffer_load_dwordx4 v10, s[52:55], s3 offen lds
    s_add_u32 m0, s63, 40960
    s_add_u32 s3, s60, 65536
    buffer_load_dwordx4 v10, s[52:55], s3 offen lds
    s_add_u32 m0, s63, 45056
    s_add_u32 s3, s60, 73728
    buffer_load_dwordx4 v10, s[52:55], s3 offen lds
    s_add_u32 m0, s63, 49152
    s_add_u32 s3, s60, 81920
    buffer_load_dwordx4 v10, s[52:55], s3 offen lds
    s_add_u32 m0, s63, 53248
    s_add_u32 s3, s60, 90112
    buffer_load_dwordx4 v10, s[52:55], s3 offen lds
    s_add_u32 m0, s63, 57344
    s_add_u32 s3, s60, 98304
    buffer_load_dwordx4 v10, s[52:55], s3 offen lds
    s_add_u32 m0, s63, 61440
    s_add_u32 s3, s60, 106496
    buffer_load_dwordx4 v10, s[52:55], s3 offen lds
    s_add_u32 m0, s63, 0
    s_add_u32 s3, s60, 114688
    buffer_load_dwordx4 v10, s[52:55], s3 offen lds
    s_add_u32 m0, s63, 4096
    s_add_u32 s3, s60, 122880
    buffer_load_dwordx4 v10, s[52:55], s3 offen lds
    s_waitcnt vmcnt(14)
    ds_read_b64_tr_b16 v[120:121], v8 offset:8192
    ds_read_b64_tr_b16 v[122:123], v8 offset:8704
    ds_read_b64_tr_b16 v[124:125], v9 offset:8192
    ds_read_b64_tr_b16 v[126:127], v9 offset:8704
    s_waitcnt vmcnt(12)
    ds_read_b64_tr_b16 v[152:153], v8 offset:16384
    ds_read_b64_tr_b16 v[154:155], v8 offset:16896
    ds_read_b64_tr_b16 v[156:157], v9 offset:16384
    ds_read_b64_tr_b16 v[158:159], v9 offset:16896
    s_waitcnt lgkmcnt(4)
    s_add_u32 m0, s63, 8192
    s_add_u32 s3, s60, 131072
    buffer_load_dwordx4 v10, s[52:55], s3 offen lds
    s_add_u32 m0, s63, 12288
    s_add_u32 s3, s60, 139264
    buffer_load_dwordx4 v10, s[52:55], s3 offen lds
    s_waitcnt vmcnt(12)
    ds_read_b64_tr_b16 v[184:185], v8 offset:24576
    ds_read_b64_tr_b16 v[186:187], v8 offset:25088
    ds_read_b64_tr_b16 v[188:189], v9 offset:24576
    ds_read_b64_tr_b16 v[190:191], v9 offset:25088
    s_waitcnt lgkmcnt(4)
    s_add_u32 m0, s63, 16384
    s_add_u32 s3, s60, 147456
    buffer_load_dwordx4 v10, s[52:55], s3 offen lds
    s_add_u32 m0, s63, 20480
    s_add_u32 s3, s60, 155648
    buffer_load_dwordx4 v10, s[52:55], s3 offen lds
    s_waitcnt vmcnt(12)
    ds_read_b64_tr_b16 v[216:217], v8 offset:32768
    ds_read_b64_tr_b16 v[218:219], v8 offset:33280
    ds_read_b64_tr_b16 v[220:221], v9 offset:32768
    ds_read_b64_tr_b16 v[222:223], v9 offset:33280
    s_waitcnt lgkmcnt(4)
    s_add_u32 m0, s63, 24576
    s_add_u32 s3, s60, 163840
    buffer_load_dwordx4 v10, s[52:55], s3 offen lds
    s_add_u32 m0, s63, 28672
    s_add_u32 s3, s60, 172032
    buffer_load_dwordx4 v10, s[52:55], s3 offen lds
    s_waitcnt vmcnt(12)
    ds_read_b64_tr_b16 v[128:129], v8 offset:40960
    ds_read_b64_tr_b16 v[130:131], v8 offset:41472
    ds_read_b64_tr_b16 v[132:133], v9 offset:40960
    ds_read_b64_tr_b16 v[134:135], v9 offset:41472
    s_waitcnt lgkmcnt(4)
    s_add_u32 m0, s63, 32768
    s_add_u32 s3, s60, 180224
    buffer_load_dwordx4 v10, s[52:55], s3 offen lds
    s_add_u32 m0, s63, 36864
    s_add_u32 s3, s60, 188416
    buffer_load_dwordx4 v10, s[52:55], s3 offen lds
    s_waitcnt vmcnt(12)
    ds_read_b64_tr_b16 v[160:161], v8 offset:49152
    ds_read_b64_tr_b16 v[162:163], v8 offset:49664
    ds_read_b64_tr_b16 v[164:165], v9 offset:49152
    ds_read_b64_tr_b16 v[166:167], v9 offset:49664
    s_waitcnt lgkmcnt(4)
    s_add_u32 m0, s63, 40960
    s_add_u32 s3, s60, 196608
    buffer_load_dwordx4 v10, s[52:55], s3 offen lds
    s_add_u32 m0, s63, 45056
    s_add_u32 s3, s60, 204800
    buffer_load_dwordx4 v10, s[52:55], s3 offen lds
    s_waitcnt vmcnt(12)
    ds_read_b64_tr_b16 v[192:193], v8 offset:57344
    ds_read_b64_tr_b16 v[194:195], v8 offset:57856
    ds_read_b64_tr_b16 v[196:197], v9 offset:57344
    ds_read_b64_tr_b16 v[198:199], v9 offset:57856
    s_waitcnt lgkmcnt(4)
    s_add_u32 m0, s63, 49152
    s_add_u32 s3, s60, 212992
    buffer_load_dwordx4 v10, s[52:55], s3 offen lds
    s_add_u32 m0, s63, 53248
    s_add_u32 s3, s60, 221184
    buffer_load_dwordx4 v10, s[52:55], s3 offen lds
    s_waitcnt vmcnt(12)
    ds_read_b64_tr_b16 v[224:225], v8 offset:0
    ds_read_b64_tr_b16 v[226:227], v8 offset:512
    ds_read_b64_tr_b16 v[228:229], v9 offset:0
    ds_read_b64_tr_b16 v[230:231], v9 offset:512
    s_waitcnt lgkmcnt(4)
    s_add_u32 m0, s63, 57344
    s_add_u32 s3, s60, 229376
    buffer_load_dwordx4 v10, s[52:55], s3 offen lds
    s_add_u32 m0, s63, 61440
    s_add_u32 s3, s60, 237568
    buffer_load_dwordx4 v10, s[52:55], s3 offen lds
    s_waitcnt vmcnt(12)
    ds_read_b64_tr_b16 v[136:137], v8 offset:8192
    ds_read_b64_tr_b16 v[138:139], v8 offset:8704
    ds_read_b64_tr_b16 v[140:141], v9 offset:8192
    ds_read_b64_tr_b16 v[142:143], v9 offset:8704
    s_waitcnt lgkmcnt(4)
    s_add_u32 m0, s63, 0
    s_add_u32 s3, s62, 0
    buffer_load_dwordx4 v13, s[48:51], s3 offen lds
    s_add_u32 m0, s63, 4096
    s_add_u32 s3, s62, 57344
    buffer_load_dwordx4 v13, s[48:51], s3 offen lds
    s_waitcnt vmcnt(12)
    ds_read_b64_tr_b16 v[168:169], v8 offset:16384
    ds_read_b64_tr_b16 v[170:171], v8 offset:16896
    ds_read_b64_tr_b16 v[172:173], v9 offset:16384
    ds_read_b64_tr_b16 v[174:175], v9 offset:16896
    s_waitcnt lgkmcnt(4)
    s_add_u32 m0, s63, 8192
    s_add_u32 s3, s62, 114688
    buffer_load_dwordx4 v13, s[48:51], s3 offen lds
    s_add_u32 m0, s63, 12288
    s_add_u32 s3, s62, 172032
    buffer_load_dwordx4 v13, s[48:51], s3 offen lds
    s_waitcnt vmcnt(12)
    ds_read_b64_tr_b16 v[200:201], v8 offset:24576
    ds_read_b64_tr_b16 v[202:203], v8 offset:25088
    ds_read_b64_tr_b16 v[204:205], v9 offset:24576
    ds_read_b64_tr_b16 v[206:207], v9 offset:25088
    s_waitcnt lgkmcnt(4)
    s_add_u32 m0, s63, 16384
    s_add_u32 s3, s62, 229376
    buffer_load_dwordx4 v13, s[48:51], s3 offen lds
    s_add_u32 m0, s63, 20480
    s_add_u32 s3, s62, 286720
    buffer_load_dwordx4 v13, s[48:51], s3 offen lds
    s_waitcnt vmcnt(12)
    ds_read_b64_tr_b16 v[232:233], v8 offset:32768
    ds_read_b64_tr_b16 v[234:235], v8 offset:33280
    ds_read_b64_tr_b16 v[236:237], v9 offset:32768
    ds_read_b64_tr_b16 v[238:239], v9 offset:33280
    s_waitcnt lgkmcnt(4)
    s_add_u32 m0, s63, 24576
    s_add_u32 s3, s62, 344064
    buffer_load_dwordx4 v13, s[48:51], s3 offen lds
    s_add_u32 m0, s63, 28672
    s_add_u32 s3, s62, 401408
    buffer_load_dwordx4 v13, s[48:51], s3 offen lds
    s_waitcnt vmcnt(12)
    ds_read_b64_tr_b16 v[144:145], v8 offset:40960
    ds_read_b64_tr_b16 v[146:147], v8 offset:41472
    ds_read_b64_tr_b16 v[148:149], v9 offset:40960
    ds_read_b64_tr_b16 v[150:151], v9 offset:41472
    s_waitcnt lgkmcnt(4)
    s_add_u32 m0, s63, 32768
    s_add_u32 s3, s62, 458752
    buffer_load_dwordx4 v13, s[48:51], s3 offen lds
    s_add_u32 m0, s63, 36864
    s_add_u32 s3, s62, 516096
    buffer_load_dwordx4 v13, s[48:51], s3 offen lds
    s_waitcnt vmcnt(12)
    ds_read_b64_tr_b16 v[176:177], v8 offset:49152
    ds_read_b64_tr_b16 v[178:179], v8 offset:49664
    ds_read_b64_tr_b16 v[180:181], v9 offset:49152
    ds_read_b64_tr_b16 v[182:183], v9 offset:49664
    s_waitcnt lgkmcnt(4)
    s_add_u32 m0, s63, 40960
    s_add_u32 s3, s62, 573440
    buffer_load_dwordx4 v13, s[48:51], s3 offen lds
    s_add_u32 m0, s63, 45056
    s_add_u32 s3, s62, 630784
    buffer_load_dwordx4 v13, s[48:51], s3 offen lds
    s_waitcnt vmcnt(12)
    ds_read_b64_tr_b16 v[208:209], v8 offset:57344
    ds_read_b64_tr_b16 v[210:211], v8 offset:57856
    ds_read_b64_tr_b16 v[212:213], v9 offset:57344
    ds_read_b64_tr_b16 v[214:215], v9 offset:57856
    s_waitcnt lgkmcnt(4)
    s_add_u32 m0, s63, 49152
    s_add_u32 s3, s62, 688128
    buffer_load_dwordx4 v13, s[48:51], s3 offen lds
    s_add_u32 m0, s63, 53248
    s_add_u32 s3, s62, 745472
    buffer_load_dwordx4 v13, s[48:51], s3 offen lds
    v_lshlrev_b32 v16, 4, v1
    s_and_b32 s3, s65, 12
    s_add_u32 s3, s3, s56
    s_lshl_b32 s47, s3, 10
    s_add_u32 s47, s47, 0x40000
    buffer_load_dword v17, v16, s[40:43], s47 offen sc1
    s_waitcnt lgkmcnt(0)
    s_add_u32 m0, s63, 57344
    s_add_u32 s3, s62, 802816
    buffer_load_dwordx4 v13, s[48:51], s3 offen lds
    s_add_u32 m0, s63, 61440
    s_add_u32 s3, s62, 860160
    buffer_load_dwordx4 v13, s[48:51], s3 offen lds
    s_waitcnt vmcnt(2)
    v_cmp_ne_u32 vcc, s5, v17
    s_cbranch_vccnz L_pf_retry
L_pf_ok:
    s_barrier
    s_add_u32 m0, s67, 0
    s_add_u32 s3, s64, 0
    buffer_load_dwordx4 v14, s[40:43], s3 offen sc1 lds
    s_add_u32 m0, s67, 1024
    s_add_u32 s3, s64, 65536
    buffer_load_dwordx4 v14, s[40:43], s3 offen sc1 lds
    s_add_u32 m0, s67, 2048
    s_add_u32 s3, s64, 131072
    buffer_load_dwordx4 v14, s[40:43], s3 offen sc1 lds
    s_add_u32 m0, s67, 3072
    s_add_u32 s3, s64, 196608
    buffer_load_dwordx4 v14, s[40:43], s3 offen sc1 lds
    s_add_u32 m0, s67, 16384
    s_add_u32 s3, s64, 262144
    buffer_load_dwordx4 v14, s[40:43], s3 offen sc1 lds
    s_add_u32 m0, s67, 17408
    s_add_u32 s3, s64, 327680
    buffer_load_dwordx4 v14, s[40:43], s3 offen sc1 lds
    s_add_u32 m0, s67, 18432
    s_add_u32 s3, s64, 393216
    buffer_load_dwordx4 v14, s[40:43], s3 offen sc1 lds
    s_add_u32 m0, s67, 19456
    s_add_u32 s3, s64, 458752
    buffer_load_dwordx4 v14, s[40:43], s3 offen sc1 lds
    s_add_u32 m0, s67, 32768
    s_add_u32 s3, s64, 524288
    buffer_load_dwordx4 v14, s[40:43], s3 offen sc1 lds
    s_add_u32 m0, s67, 33792
    s_add_u32 s3, s64, 589824
    buffer_load_dwordx4 v14, s[40:43], s3 offen sc1 lds
    s_add_u32 m0, s67, 34816
    s_add_u32 s3, s64, 655360
    buffer_load_dwordx4 v14, s[40:43], s3 offen sc1 lds
    s_add_u32 m0, s67, 35840
    s_add_u32 s3, s64, 720896
    buffer_load_dwordx4 v14, s[40:43], s3 offen sc1 lds
    s_waitcnt vmcnt(8)
    s_barrier
    s_add_u32 m0, s67, 49152
    s_add_u32 s3, s64, 786432
    buffer_load_dwordx4 v14, s[40:43], s3 offen sc1 lds
    s_add_u32 m0, s67, 50176
    s_add_u32 s3, s64, 851968
    buffer_load_dwordx4 v14, s[40:43], s3 offen sc1 lds
    s_add_u32 m0, s67, 51200
    s_add_u32 s3, s64, 917504
    buffer_load_dwordx4 v14, s[40:43], s3 offen sc1 lds
    s_add_u32 m0, s67, 52224
    s_add_u32 s3, s64, 983040
    buffer_load_dwordx4 v14, s[40:43], s3 offen sc1 lds
    s_waitcnt vmcnt(8)
    s_barrier
    s_add_u32 m0, s67, 65536
    s_add_u32 s3, s64, 1048576
    buffer_load_dwordx4 v14, s[40:43], s3 offen sc1 lds
    s_add_u32 m0, s67, 66560
    s_add_u32 s3, s64, 1114112
    buffer_load_dwordx4 v14, s[40:43], s3 offen sc1 lds
    s_add_u32 m0, s67, 67584
    s_add_u32 s3, s64, 1179648
    buffer_load_dwordx4 v14, s[40:43], s3 offen sc1 lds
    s_add_u32 m0, s67, 68608
    s_add_u32 s3, s64, 1245184
    buffer_load_dwordx4 v14, s[40:43], s3 offen sc1 lds
    s_waitcnt vmcnt(8)
    s_barrier
    s_add_u32 m0, s67, 0
    s_add_u32 s3, s64, 1310720
    buffer_load_dwordx4 v14, s[40:43], s3 offen sc1 lds
    s_add_u32 m0, s67, 1024
    s_add_u32 s3, s64, 1376256
    buffer_load_dwordx4 v14, s[40:43], s3 offen sc1 lds
    s_add_u32 m0, s67, 2048
    s_add_u32 s3, s64, 1441792
    buffer_load_dwordx4 v14, s[40:43], s3 offen sc1 lds
    s_add_u32 m0, s67, 3072
    s_add_u32 s3, s64, 1507328
    buffer_load_dwordx4 v14, s[40:43], s3 offen sc1 lds
    s_waitcnt vmcnt(8)
    s_barrier
    s_add_u32 m0, s67, 16384
    s_add_u32 s3, s64, 1572864
    buffer_load_dwordx4 v14, s[40:43], s3 offen sc1 lds
    s_add_u32 m0, s67, 17408
    s_add_u32 s3, s64, 1638400
    buffer_load_dwordx4 v14, s[40:43], s3 offen sc1 lds
    s_add_u32 m0, s67, 18432
    s_add_u32 s3, s64, 1703936
    buffer_load_dwordx4 v14, s[40:43], s3 offen sc1 lds
    s_add_u32 m0, s67, 19456
    s_add_u32 s3, s64, 1769472
    buffer_load_dwordx4 v14, s[40:43], s3 offen sc1 lds
    s_waitcnt vmcnt(8)
    s_barrier
    s_add_u32 m0, s67, 32768
    s_add_u32 s3, s64, 1835008
    buffer_load_dwordx4 v14, s[40:43], s3 offen sc1 lds
    s_add_u32 m0, s67, 33792
    s_add_u32 s3, s64, 1900544
    buffer_load_dwordx4 v14, s[40:43], s3 offen sc1 lds
    s_add_u32 m0, s67, 34816
    s_add_u32 s3, s64, 1966080
    buffer_load_dwordx4 v14, s[40:43], s3 offen sc1 lds
    s_add_u32 m0, s67, 35840
    s_add_u32 s3, s64, 2031616
    buffer_load_dwordx4 v14, s[40:43], s3 offen sc1 lds
    s_add_u32 m0, s63, 65536
    s_add_u32 s3, s62, 917504
    buffer_load_dwordx4 v13, s[48:51], s3 offen lds
    s_add_u32 m0, s63, 69632
    s_add_u32 s3, s62, 974848
    buffer_load_dwordx4 v13, s[48:51], s3 offen lds
    s_waitcnt vmcnt(10)
    s_barrier
    s_add_u32 m0, s63, 0
    s_add_u32 s3, s62, 1032192
    buffer_load_dwordx4 v13, s[48:51], s3 offen lds
    s_add_u32 m0, s63, 4096
    s_add_u32 s3, s62, 1089536
    buffer_load_dwordx4 v13, s[48:51], s3 offen lds
    s_add_u32 m0, s63, 8192
    s_add_u32 s3, s62, 1146880
    buffer_load_dwordx4 v13, s[48:51], s3 offen lds
    s_add_u32 m0, s63, 12288
    s_add_u32 s3, s62, 1204224
    buffer_load_dwordx4 v13, s[48:51], s3 offen lds
    s_add_u32 m0, s63, 16384
    s_add_u32 s3, s62, 1261568
    buffer_load_dwordx4 v13, s[48:51], s3 offen lds
    s_waitcnt vmcnt(11)
    s_barrier
    s_add_u32 m0, s63, 20480
    s_add_u32 s3, s62, 1318912
    buffer_load_dwordx4 v13, s[48:51], s3 offen lds
    s_add_u32 m0, s63, 24576
    s_add_u32 s3, s62, 1376256
    buffer_load_dwordx4 v13, s[48:51], s3 offen lds
    s_add_u32 m0, s63, 28672
    s_add_u32 s3, s62, 1433600
    buffer_load_dwordx4 v13, s[48:51], s3 offen lds
    s_add_u32 m0, s63, 32768
    s_add_u32 s3, s62, 1490944
    buffer_load_dwordx4 v13, s[48:51], s3 offen lds
    s_add_u32 m0, s63, 36864
    s_add_u32 s3, s62, 1548288
    buffer_load_dwordx4 v13, s[48:51], s3 offen lds
    buffer_load_dwordx2 v[16:17], v4, s[40:43], s57 offen sc1
    buffer_load_dwordx2 v[18:19], v5, s[40:43], s57 offen sc1
    buffer_load_dwordx2 v[20:21], v4, s[40:43], s58 offen sc1
    buffer_load_dwordx2 v[22:23], v5, s[40:43], s58 offen sc1
    s_waitcnt vmcnt(12)
    s_barrier
    s_add_u32 m0, s63, 40960
    s_add_u32 s3, s62, 1605632
    buffer_load_dwordx4 v13, s[48:51], s3 offen lds
    s_add_u32 m0, s63, 45056
    s_add_u32 s3, s62, 1662976
    buffer_load_dwordx4 v13, s[48:51], s3 offen lds
    s_add_u32 m0, s63, 49152
    s_add_u32 s3, s62, 1720320
    buffer_load_dwordx4 v13, s[48:51], s3 offen lds
    s_add_u32 m0, s63, 53248
    s_add_u32 s3, s62, 1777664
    buffer_load_dwordx4 v13, s[48:51], s3 offen lds
    s_waitcnt vmcnt(4)
    v_xor_b32 v17, s5, v17
    v_xor_b32 v19, s5, v19
    v_xor_b32 v21, s5, v21
    v_xor_b32 v23, s5, v23
    v_or3_b32 v17, v17, v19, v21
    v_or_b32 v17, v17, v23
    v_cmp_ne_u32 vcc, 0, v17
    s_cbranch_vccnz L_csc_retry
L_csc_ok:
    v_add_f32 v16, v16, v18
    v_add_f32 v18, v20, v22
    v_mov_b32 v17, v16
    v_mov_b32 v19, v18
    s_nop 0
    v_permlane32_swap_b32 v16, v17
    v_permlane32_swap_b32 v18, v19
    v_add_f32 v16, v16, v17
    v_add_f32 v18, v18, v19
    v_cvt_pk_bf16_f32 v17, v16, v16
    v_cvt_pk_bf16_f32 v19, v18, v18
    v_and_b32 v20, s59, v17
    v_and_b32 v21, s59, v19
    v_sub_f32 v16, v16, v20
    v_sub_f32 v18, v18, v21
    v_cvt_pk_bf16_f32 v16, v20, v16
    v_cvt_pk_bf16_f32 v18, v21, v18
    v_and_b32 v2, 31, v1
    s_lshl_b32 s3, s56, 7
    s_add_u32 s3, s3, 159744
    v_lshl_add_u32 v2, v2, 2, s3
    ds_write_b32 v2, v16
    ds_write_b32 v2, v18 offset:512
    s_waitcnt lgkmcnt(0)
    s_waitcnt vmcnt(0)
    s_barrier
    s_add_u32 m0, s63, 94208
    s_add_u32 s3, s68, 0
    buffer_load_dwordx4 v6, s[40:43], s3 offen sc1 lds
    s_add_u32 m0, s63, 98304
    s_add_u32 s3, s68, 2048
    buffer_load_dwordx4 v6, s[40:43], s3 offen sc1 lds
    s_add_u32 m0, s63, 102400
    s_add_u32 s3, s68, 4096
    buffer_load_dwordx4 v6, s[40:43], s3 offen sc1 lds
    s_add_u32 m0, s63, 106496
    s_add_u32 s3, s68, 6144
    buffer_load_dwordx4 v6, s[40:43], s3 offen sc1 lds
    s_add_u32 m0, s63, 110592
    s_add_u32 s3, s68, 8192
    buffer_load_dwordx4 v6, s[40:43], s3 offen sc1 lds
    s_add_u32 m0, s63, 114688
    s_add_u32 s3, s68, 10240
    buffer_load_dwordx4 v6, s[40:43], s3 offen sc1 lds
    s_add_u32 m0, s63, 118784
    s_add_u32 s3, s68, 12288
    buffer_load_dwordx4 v6, s[40:43], s3 offen sc1 lds
    s_add_u32 m0, s63, 122880
    s_add_u32 s3, s68, 14336
    buffer_load_dwordx4 v6, s[40:43], s3 offen sc1 lds
    s_add_u32 m0, s63, 126976
    s_add_u32 s3, s68, 32768
    buffer_load_dwordx4 v6, s[40:43], s3 offen sc1 lds
    s_add_u32 m0, s63, 131072
    s_add_u32 s3, s68, 34816
    buffer_load_dwordx4 v6, s[40:43], s3 offen sc1 lds
    s_add_u32 m0, s63, 135168
    s_add_u32 s3, s68, 36864
    buffer_load_dwordx4 v6, s[40:43], s3 offen sc1 lds
    s_add_u32 m0, s63, 139264
    s_add_u32 s3, s68, 38912
    buffer_load_dwordx4 v6, s[40:43], s3 offen sc1 lds
    s_add_u32 m0, s63, 143360
    s_add_u32 s3, s68, 40960
    buffer_load_dwordx4 v6, s[40:43], s3 offen sc1 lds
    s_add_u32 m0, s63, 147456
    s_add_u32 s3, s68, 43008
    buffer_load_dwordx4 v6, s[40:43], s3 offen sc1 lds
    s_add_u32 m0, s63, 151552
    s_add_u32 s3, s68, 45056
    buffer_load_dwordx4 v6, s[40:43], s3 offen sc1 lds
    s_add_u32 m0, s63, 155648
    s_add_u32 s3, s68, 47104
    buffer_load_dwordx4 v6, s[40:43], s3 offen sc1 lds
    v_mov_b32 v2, 0x27458
    s_branch L_g_c24_t
L_g_c24:
    s_add_u32 s0, s0, 1
    s_cmp_gt_u32 s0, 4194304
    s_cbranch_scc1 L_g_c24_x
L_g_c24_t:
    ds_read_b32 v3, v2
    s_waitcnt lgkmcnt(0)
    v_cmp_gt_u32 vcc, 64, v3
    s_cbranch_vccnz L_g_c24
L_g_c24_x:
    s_add_u32 m0, s63, 61440
    s_add_u32 s3, s68, 65536
    buffer_load_dwordx4 v6, s[40:43], s3 offen sc1 lds
    s_add_u32 m0, s63, 65536
    s_add_u32 s3, s68, 67584
    buffer_load_dwordx4 v6, s[40:43], s3 offen sc1 lds
    s_add_u32 m0, s63, 69632
    s_add_u32 s3, s68, 69632
    buffer_load_dwordx4 v6, s[40:43], s3 offen sc1 lds
    s_add_u32 m0, s63, 73728
    s_add_u32 s3, s68, 71680
    buffer_load_dwordx4 v6, s[40:43], s3 offen sc1 lds
    s_add_u32 m0, s63, 77824
    s_add_u32 s3, s68, 73728
    buffer_load_dwordx4 v6, s[40:43], s3 offen sc1 lds
    s_add_u32 m0, s63, 81920
    s_add_u32 s3, s68, 75776
    buffer_load_dwordx4 v6, s[40:43], s3 offen sc1 lds
    s_add_u32 m0, s63, 86016
    s_add_u32 s3, s68, 77824
    buffer_load_dwordx4 v6, s[40:43], s3 offen sc1 lds
    s_add_u32 m0, s63, 90112
    s_add_u32 s3, s68, 79872
    buffer_load_dwordx4 v6, s[40:43], s3 offen sc1 lds
    s_mov_b32 s64, 8192
    s_lshl_b32 s57, s65, 2
    s_and_b32 s3, s66, 1
    s_lshl_b32 s3, s3, 1
    s_add_u32 s57, s57, s3
    s_mul_i32 s57, s57, 114688
    v_add_u32 v8, s57, v7
    v_add_u32 v9, 114688, v8
    s_mul_i32 s44, s56, 12288
    s_add_u32 s44, s44, 0x610000
    s_lshl_b32 s48, s56, 14
    s_add_u32 s48, s48, 0x600000
    s_add_u32 s49, s48, 4096
    s_add_u32 s45, s44, 3072
    s_add_u32 s50, s48, 8192
    s_add_u32 s46, s44, 6144
    s_add_u32 s51, s48, 12288
    s_add_u32 s47, s44, 9216
    v_add_u32 v13, 0x10000, v11
    v_add_u32 v14, 0x10000, v12
    s_lshl_b32 s67, s56, 11
    s_waitcnt vmcnt(8)
    s_barrier
    s_mul_i32 s3, s64, 30
    s_add_u32 m0, s67, 0
    s_add_u32 s3, s3, s60
    buffer_load_dwordx4 v10, s[52:55], s3 offen sc1 lds
    s_mul_i32 s3, s64, 31
    s_add_u32 m0, s67, 1024
    s_add_u32 s3, s3, s60
    buffer_load_dwordx4 v10, s[52:55], s3 offen sc1 lds
    s_mul_i32 s3, s64, 0
    s_add_u32 m0, s67, 8192
    s_add_u32 s3, s3, s61
    buffer_load_dwordx4 v10, s[52:55], s3 offen sc1 lds
    s_mul_i32 s3, s64, 1
    s_add_u32 m0, s67, 9216
    s_add_u32 s3, s3, s61
    buffer_load_dwordx4 v10, s[52:55], s3 offen sc1 lds
    s_mul_i32 s3, s64, 18
    s_add_u32 m0, s67, 16384
    s_add_u32 s3, s3, s61
    buffer_load_dwordx4 v10, s[52:55], s3 offen sc1 lds
    s_mul_i32 s3, s64, 19
    s_add_u32 m0, s67, 17408
    s_add_u32 s3, s3, s61
    buffer_load_dwordx4 v10, s[52:55], s3 offen sc1 lds
    s_mul_i32 s3, s64, 2
    s_add_u32 m0, s67, 24576
    s_add_u32 s3, s3, s61
    buffer_load_dwordx4 v10, s[52:55], s3 offen sc1 lds
    s_mul_i32 s3, s64, 3
    s_add_u32 m0, s67, 25600
    s_add_u32 s3, s3, s61
    buffer_load_dwordx4 v10, s[52:55], s3 offen sc1 lds
    s_mul_i32 s3, s64, 8
    s_add_u32 m0, s67, 32768
    s_add_u32 s3, s3, s61
    buffer_load_dwordx4 v10, s[52:55], s3 offen sc1 lds
    s_mul_i32 s3, s64, 9
    s_add_u32 m0, s67, 33792
    s_add_u32 s3, s3, s61
    buffer_load_dwordx4 v10, s[52:55], s3 offen sc1 lds
    s_mul_i32 s3, s64, 14
    s_add_u32 m0, s67, 40960
    s_add_u32 s3, s3, s61
    buffer_load_dwordx4 v10, s[52:55], s3 offen sc1 lds
    s_mul_i32 s3, s64, 15
    s_add_u32 m0, s67, 41984
    s_add_u32 s3, s3, s61
    buffer_load_dwordx4 v10, s[52:55], s3 offen sc1 lds
    s_mul_i32 s3, s64, 20
    s_add_u32 m0, s67, 49152
    s_add_u32 s3, s3, s61
    buffer_load_dwordx4 v10, s[52:55], s3 offen sc1 lds
    s_mul_i32 s3, s64, 21
    s_add_u32 m0, s67, 50176
    s_add_u32 s3, s3, s61
    buffer_load_dwordx4 v10, s[52:55], s3 offen sc1 lds
    s_waitcnt vmcnt(14)
    v_mov_b32 v2, 0x2743c
    v_mov_b32 v3, 1
    s_mov_b64 exec, 1
    ds_add_u32 v2, v3
    s_mov_b64 exec, -1
    s_waitcnt vmcnt(12)
    ds_read_b64_tr_b16 v[240:241], v11 offset:0
    ds_read_b64_tr_b16 v[242:243], v11 offset:512
    ds_read_b64_tr_b16 v[244:245], v12 offset:0
    ds_read_b64_tr_b16 v[246:247], v12 offset:512
    s_waitcnt vmcnt(10)
    ds_read_b64_tr_b16 v[248:249], v11 offset:8192
    ds_read_b64_tr_b16 v[250:251], v11 offset:8704
    ds_read_b64_tr_b16 v[252:253], v12 offset:8192
    ds_read_b64_tr_b16 v[254:255], v12 offset:8704
    s_waitcnt lgkmcnt(4)
    s_mul_i32 s3, s64, 6
    s_add_u32 m0, s67, 0
    s_add_u32 s3, s3, s61
    buffer_load_dwordx4 v10, s[52:55], s3 offen sc1 lds
    s_mul_i32 s3, s64, 7
    s_add_u32 m0, s67, 1024
    s_add_u32 s3, s3, s61
    buffer_load_dwordx4 v10, s[52:55], s3 offen sc1 lds
    s_waitcnt lgkmcnt(0)
    s_mul_i32 s3, s64, 12
    s_add_u32 m0, s67, 8192
    s_add_u32 s3, s3, s61
    buffer_load_dwordx4 v10, s[52:55], s3 offen sc1 lds
    s_mul_i32 s3, s64, 13
    s_add_u32 m0, s67, 9216
    s_add_u32 s3, s3, s61
    buffer_load_dwordx4 v10, s[52:55], s3 offen sc1 lds
    s_andn2_b32 s68, 3, s5
    s_lshl_b32 s68, s68, 2
    s_and_b32 s3, s5, 0xf3
    s_or_b32 s68, s68, s3
    v_and_b32 v2, 3, v1
    v_lshlrev_b32 v2, 1, v2
    v_lshrrev_b32 v7, v2, s68
    v_lshl_or_b32 v7, v7, 15, v7
    s_mov_b32 s68, 0x00010001
    v_and_b32 v7, s68, v7
    s_mov_b64 s[6:7], vcc
    v_mov_b32 v4, 0x27460
    s_branch L_gate1_t
L_gate1:
    s_add_u32 s0, s0, 1
    s_cmp_gt_u32 s0, 4194304
    s_cbranch_scc1 L_gate1_x
L_gate1_t:
    ds_read_b32 v5, v4
    s_waitcnt lgkmcnt(0)
    v_cmp_gt_u32 vcc, 64, v5
    s_cbranch_vccnz L_gate1
L_gate1_x:
    s_mov_b64 vcc, s[6:7]
    buffer_load_dwordx4 v[16:19], v8, s[40:43], s48 offen offset:0 sc1
    buffer_load_dwordx4 v[20:23], v9, s[40:43], s48 offen offset:0 sc1
    buffer_load_dwordx4 v[24:27], v8, s[40:43], s49 offen offset:0 sc1
    buffer_load_dwordx4 v[28:31], v9, s[40:43], s49 offen offset:0 sc1
    buffer_load_dwordx4 v[32:35], v8, s[40:43], s50 offen offset:0 sc1
    buffer_load_dwordx4 v[36:39], v9, s[40:43], s50 offen offset:0 sc1
    buffer_load_dwordx4 v[40:43], v8, s[40:43], s51 offen offset:0 sc1
    buffer_load_dwordx4 v[44:47], v9, s[40:43], s51 offen offset:0 sc1
    buffer_load_dwordx4 v[48:51], v8, s[40:43], s48 offen offset:1024 sc1
    buffer_load_dwordx4 v[52:55], v9, s[40:43], s48 offen offset:1024 sc1
    v_add_u32 v6, 0x17000, v15
    s_mov_b64 s[6:7], vcc
    v_mov_b32 v4, 0x27464
    s_branch L_gate2_t
L_gate2:
    s_add_u32 s0, s0, 1
    s_cmp_gt_u32 s0, 4194304
    s_cbranch_scc1 L_gate2_x
L_gate2_t:
    ds_read_b32 v5, v4
    s_waitcnt lgkmcnt(0)
    v_cmp_gt_u32 vcc, 64, v5
    s_cbranch_vccnz L_gate2
L_gate2_x:
    s_mov_b64 vcc, s[6:7]
    s_add_u32 m0, s67, 94208
    s_add_u32 s3, s49, 1024
    buffer_load_dwordx4 v8, s[40:43], s3 offen sc1 lds
    s_add_u32 m0, s67, 95232
    s_add_u32 s3, s49, 1024
    buffer_load_dwordx4 v9, s[40:43], s3 offen sc1 lds
    s_add_u32 m0, s67, 102400
    s_add_u32 s3, s50, 1024
    buffer_load_dwordx4 v8, s[40:43], s3 offen sc1 lds
    s_add_u32 m0, s67, 103424
    s_add_u32 s3, s50, 1024
    buffer_load_dwordx4 v9, s[40:43], s3 offen sc1 lds
    s_add_u32 m0, s67, 110592
    s_add_u32 s3, s51, 1024
    buffer_load_dwordx4 v8, s[40:43], s3 offen sc1 lds
    s_add_u32 m0, s67, 111616
    s_add_u32 s3, s51, 1024
    buffer_load_dwordx4 v9, s[40:43], s3 offen sc1 lds
    s_add_u32 m0, s67, 118784
    s_add_u32 s3, s48, 2048
    buffer_load_dwordx4 v8, s[40:43], s3 offen sc1 lds
    s_add_u32 m0, s67, 119808
    s_add_u32 s3, s48, 2048
    buffer_load_dwordx4 v9, s[40:43], s3 offen sc1 lds
    s_mov_b64 s[6:7], vcc
    v_mov_b32 v4, 0x27468
    s_branch L_gate3_t
L_gate3:
    s_add_u32 s0, s0, 1
    s_cmp_gt_u32 s0, 4194304
    s_cbranch_scc1 L_gate3_x
L_gate3_t:
    ds_read_b32 v5, v4
    s_waitcnt lgkmcnt(0)
    v_cmp_gt_u32 vcc, 64, v5
    s_cbranch_vccnz L_gate3
L_gate3_x:
    s_mov_b64 vcc, s[6:7]
    s_add_u32 m0, s67, 126976
    s_add_u32 s3, s49, 2048
    buffer_load_dwordx4 v8, s[40:43], s3 offen sc1 lds
    s_add_u32 m0, s67, 128000
    s_add_u32 s3, s49, 2048
    buffer_load_dwordx4 v9, s[40:43], s3 offen sc1 lds
    s_add_u32 m0, s67, 135168
    s_add_u32 s3, s50, 2048
    buffer_load_dwordx4 v8, s[40:43], s3 offen sc1 lds
    s_add_u32 m0, s67, 136192
    s_add_u32 s3, s50, 2048
    buffer_load_dwordx4 v9, s[40:43], s3 offen sc1 lds
    s_add_u32 m0, s67, 143360
    s_add_u32 s3, s51, 2048
    buffer_load_dwordx4 v8, s[40:43], s3 offen sc1 lds
    s_add_u32 m0, s67, 144384
    s_add_u32 s3, s51, 2048
    buffer_load_dwordx4 v9, s[40:43], s3 offen sc1 lds
    s_add_u32 m0, s67, 151552
    s_add_u32 s3, s48, 3072
    buffer_load_dwordx4 v8, s[40:43], s3 offen sc1 lds
    s_add_u32 m0, s67, 152576
    s_add_u32 s3, s48, 3072
    buffer_load_dwordx4 v9, s[40:43], s3 offen sc1 lds
    s_waitcnt vmcnt(22)
    v_xor_b32 v16, v7, v16
    v_xor_b32 v17, v7, v17
    v_xor_b32 v18, v7, v18
    v_or3_b32 v2, v16, v17, v18
    v_xor_b32 v19, v7, v19
    v_xor_b32 v20, v7, v20
    v_or3_b32 v2, v2, v19, v20
    v_xor_b32 v21, v7, v21
    v_xor_b32 v22, v7, v22
    v_or3_b32 v2, v2, v21, v22
    v_xor_b32 v23, v7, v23
    v_xor_b32 v24, v7, v24
    v_or3_b32 v2, v2, v23, v24
    v_xor_b32 v25, v7, v25
    v_xor_b32 v26, v7, v26
    v_or3_b32 v2, v2, v25, v26
    v_xor_b32 v27, v7, v27
    v_xor_b32 v28, v7, v28
    v_or3_b32 v2, v2, v27, v28
    v_xor_b32 v29, v7, v29
    v_xor_b32 v30, v7, v30
    v_or3_b32 v2, v2, v29, v30
    v_xor_b32 v31, v7, v31
    v_bitop3_b32 v2, v2, v31, s68 bitop3:0xa8
    v_cmp_ne_u32 vcc, 0, v2
    s_cbranch_vccnz L_hh0_retry
L_hh0_ok:
    v_mfma_f32_32x32x16_bf16 v[72:87], v[120:123], v[20:23], 0
    v_mfma_f32_32x32x16_bf16 v[88:103], v[124:127], v[16:19], 0
    s_waitcnt vmcnt(20)
    v_xor_b32 v32, v7, v32
    v_xor_b32 v33, v7, v33
    v_xor_b32 v34, v7, v34
    v_mfma_f32_32x32x16_bf16 v[104:119], v[124:127], v[20:23], 0
    v_or3_b32 v2, v32, v33, v34
    v_xor_b32 v35, v7, v35
    v_xor_b32 v36, v7, v36
    v_or3_b32 v2, v2, v35, v36
    v_mfma_f32_32x32x16_bf16 v[56:71], v[120:123], v[16:19], 0
    v_xor_b32 v37, v7, v37
    v_xor_b32 v38, v7, v38
    v_or3_b32 v2, v2, v37, v38
    v_xor_b32 v39, v7, v39
    buffer_load_dwordx4 v[120:123], v8, s[40:43], s49 offen offset:3072 sc1
    v_mfma_f32_32x32x16_bf16 v[72:87], v[128:131], v[28:31], v[72:87]
    buffer_load_dwordx4 v[124:127], v9, s[40:43], s49 offen offset:3072 sc1
    s_waitcnt vmcnt(20)
    v_xor_b32 v40, v7, v40
    v_or3_b32 v2, v2, v39, v40
    v_xor_b32 v41, v7, v41
    v_xor_b32 v42, v7, v42
    v_mfma_f32_32x32x16_bf16 v[88:103], v[132:135], v[24:27], v[88:103]
    v_or3_b32 v2, v2, v41, v42
    v_xor_b32 v43, v7, v43
    v_xor_b32 v44, v7, v44
    v_or3_b32 v2, v2, v43, v44
    v_xor_b32 v45, v7, v45
    v_mfma_f32_32x32x16_bf16 v[104:119], v[132:135], v[28:31], v[104:119]
    v_xor_b32 v46, v7, v46
    v_or3_b32 v2, v2, v45, v46
    v_xor_b32 v47, v7, v47
    v_bitop3_b32 v2, v2, v47, s68 bitop3:0xa8
    v_cmp_ne_u32 vcc, 0, v2
    v_mfma_f32_32x32x16_bf16 v[56:71], v[128:131], v[24:27], v[56:71]
    s_waitcnt vmcnt(16)
    ds_read_b128 v[128:131], v6 offset:0
    ds_read_b128 v[132:135], v6 offset:1024
    s_cbranch_vccnz L_hh2_retry
L_hh2_ok:
    v_mfma_f32_32x32x16_bf16 v[72:87], v[136:139], v[36:39], v[72:87]
    v_mfma_f32_32x32x16_bf16 v[88:103], v[140:143], v[32:35], v[88:103]
    v_xor_b32 v48, v7, v48
    v_xor_b32 v49, v7, v49
    v_xor_b32 v50, v7, v50
    v_mfma_f32_32x32x16_bf16 v[104:119], v[140:143], v[36:39], v[104:119]
    v_or3_b32 v2, v48, v49, v50
    v_xor_b32 v51, v7, v51
    v_xor_b32 v52, v7, v52
    v_or3_b32 v2, v2, v51, v52
    v_mfma_f32_32x32x16_bf16 v[56:71], v[136:139], v[32:35], v[56:71]
    v_xor_b32 v53, v7, v53
    v_xor_b32 v54, v7, v54
    v_or3_b32 v2, v2, v53, v54
    v_xor_b32 v55, v7, v55
    s_waitcnt vmcnt(14)
    ds_read_b128 v[32:35], v6 offset:8192
    ds_read_b128 v[36:39], v6 offset:9216
    buffer_load_dwordx4 v[136:139], v8, s[40:43], s50 offen offset:3072 sc1
    v_mfma_f32_32x32x16_bf16 v[72:87], v[144:147], v[44:47], v[72:87]
    buffer_load_dwordx4 v[140:143], v9, s[40:43], s50 offen offset:3072 sc1
    s_waitcnt lgkmcnt(2)
    v_xor_b32 v128, v7, v128
    v_or3_b32 v2, v2, v55, v128
    v_xor_b32 v129, v7, v129
    v_xor_b32 v130, v7, v130
    v_mfma_f32_32x32x16_bf16 v[88:103], v[148:151], v[40:43], v[88:103]
    v_or3_b32 v2, v2, v129, v130
    v_xor_b32 v131, v7, v131
    v_xor_b32 v132, v7, v132
    v_or3_b32 v2, v2, v131, v132
    v_xor_b32 v133, v7, v133
    v_mfma_f32_32x32x16_bf16 v[104:119], v[148:151], v[44:47], v[104:119]
    v_xor_b32 v134, v7, v134
    v_or3_b32 v2, v2, v133, v134
    v_xor_b32 v135, v7, v135
    v_bitop3_b32 v2, v2, v135, s68 bitop3:0xa8
    v_cmp_ne_u32 vcc, 0, v2
    v_mfma_f32_32x32x16_bf16 v[56:71], v[144:147], v[40:43], v[56:71]
    s_waitcnt vmcnt(14)
    ds_read_b128 v[40:43], v6 offset:16384
    ds_read_b128 v[44:47], v6 offset:17408
    buffer_load_dwordx4 v[144:147], v8, s[40:43], s51 offen offset:3072 sc1
    s_cbranch_vccnz L_hh4_retry
L_hh4_ok:
    v_mfma_f32_32x32x16_bf16 v[72:87], v[152:155], v[52:55], v[72:87]
    buffer_load_dwordx4 v[148:151], v9, s[40:43], s51 offen offset:3072 sc1
    v_mfma_f32_32x32x16_bf16 v[88:103], v[156:159], v[48:51], v[88:103]
    s_waitcnt lgkmcnt(2)
    v_xor_b32 v32, v7, v32
    v_xor_b32 v33, v7, v33
    v_xor_b32 v34, v7, v34
    v_mfma_f32_32x32x16_bf16 v[104:119], v[156:159], v[52:55], v[104:119]
    v_or3_b32 v2, v32, v33, v34
    v_xor_b32 v35, v7, v35
    v_xor_b32 v36, v7, v36
    v_or3_b32 v2, v2, v35, v36
    v_mfma_f32_32x32x16_bf16 v[56:71], v[152:155], v[48:51], v[56:71]
    v_xor_b32 v37, v7, v37
    v_xor_b32 v38, v7, v38
    v_or3_b32 v2, v2, v37, v38
    v_xor_b32 v39, v7, v39
    s_setprio 3
    s_waitcnt vmcnt(14)
    ds_read_b128 v[48:51], v6 offset:24576
    ds_read_b128 v[52:55], v6 offset:25600
    s_mov_b64 s[6:7], vcc
    v_mov_b32 v4, 0x2746c
    s_branch L_gate4_t
L_gate4:
    s_add_u32 s0, s0, 1
    s_cmp_gt_u32 s0, 4194304
    s_cbranch_scc1 L_gate4_x
L_gate4_t:
    ds_read_b32 v5, v4
    s_waitcnt lgkmcnt(0)
    v_cmp_gt_u32 vcc, 64, v5
    s_cbranch_vccnz L_gate4
L_gate4_x:
    s_mov_b64 vcc, s[6:7]
    buffer_load_dwordx4 v[152:155], v8, s[40:43], s44 offen offset:0 sc1
    v_mfma_f32_32x32x16_bf16 v[72:87], v[160:163], v[132:135], v[72:87]
    buffer_load_dwordx4 v[156:159], v9, s[40:43], s44 offen offset:0 sc1
    v_xor_b32 v40, v7, v40
    v_or3_b32 v2, v2, v39, v40
    v_xor_b32 v41, v7, v41
    v_xor_b32 v42, v7, v42
    v_mfma_f32_32x32x16_bf16 v[88:103], v[164:167], v[128:131], v[88:103]
    v_or3_b32 v2, v2, v41, v42
    v_xor_b32 v43, v7, v43
    v_xor_b32 v44, v7, v44
    v_or3_b32 v2, v2, v43, v44
    v_xor_b32 v45, v7, v45
    v_mfma_f32_32x32x16_bf16 v[104:119], v[164:167], v[132:135], v[104:119]
    s_mul_i32 s3, s64, 4
    s_add_u32 m0, s67, 61440
    s_add_u32 s3, s3, s61
    buffer_load_dwordx4 v10, s[52:55], s3 offen sc1 lds
    v_xor_b32 v46, v7, v46
    v_or3_b32 v2, v2, v45, v46
    v_xor_b32 v47, v7, v47
    v_bitop3_b32 v2, v2, v47, s68 bitop3:0xa8
    v_cmp_ne_u32 vcc, 0, v2
    v_mfma_f32_32x32x16_bf16 v[56:71], v[160:163], v[128:131], v[56:71]
    s_waitcnt vmcnt(15)
    ds_read_b128 v[128:131], v6 offset:32768
    ds_read_b128 v[132:135], v6 offset:33792
    s_mul_i32 s3, s64, 5
    s_add_u32 m0, s67, 62464
    s_add_u32 s3, s3, s61
    buffer_load_dwordx4 v10, s[52:55], s3 offen sc1 lds
    s_cbranch_vccnz L_hh6_retry
L_hh6_ok:
    v_mfma_f32_32x32x16_bf16 v[72:87], v[168:171], v[36:39], v[72:87]
    s_mul_i32 s3, s64, 10
    s_add_u32 m0, s67, 69632
    s_add_u32 s3, s3, s61
    buffer_load_dwordx4 v10, s[52:55], s3 offen sc1 lds
    v_mfma_f32_32x32x16_bf16 v[88:103], v[172:175], v[32:35], v[88:103]
    s_mul_i32 s3, s64, 11
    s_add_u32 m0, s67, 70656
    s_add_u32 s3, s3, s61
    buffer_load_dwordx4 v10, s[52:55], s3 offen sc1 lds
    v_xor_b32 v48, v7, v48
    v_xor_b32 v49, v7, v49
    v_xor_b32 v50, v7, v50
    v_mfma_f32_32x32x16_bf16 v[104:119], v[172:175], v[36:39], v[104:119]
    s_mul_i32 s3, s64, 16
    s_add_u32 m0, s67, 77824
    s_add_u32 s3, s3, s61
    buffer_load_dwordx4 v10, s[52:55], s3 offen sc1 lds
    v_or3_b32 v2, v48, v49, v50
    v_xor_b32 v51, v7, v51
    v_xor_b32 v52, v7, v52
    v_or3_b32 v2, v2, v51, v52
    v_mfma_f32_32x32x16_bf16 v[56:71], v[168:171], v[32:35], v[56:71]
    v_xor_b32 v53, v7, v53
    v_xor_b32 v54, v7, v54
    v_or3_b32 v2, v2, v53, v54
    v_xor_b32 v55, v7, v55
    s_waitcnt vmcnt(17)
    ds_read_b128 v[32:35], v6 offset:40960
    ds_read_b128 v[36:39], v6 offset:41984
    s_mul_i32 s3, s64, 17
    s_add_u32 m0, s67, 78848
    s_add_u32 s3, s3, s61
    buffer_load_dwordx4 v10, s[52:55], s3 offen sc1 lds
    v_mfma_f32_32x32x16_bf16 v[72:87], v[176:179], v[44:47], v[72:87]
    s_mul_i32 s3, s64, 22
    s_add_u32 m0, s67, 86016
    s_add_u32 s3, s3, s61
    buffer_load_dwordx4 v10, s[52:55], s3 offen sc1 lds
    s_waitcnt lgkmcnt(2)
    v_xor_b32 v128, v7, v128
    v_or3_b32 v2, v2, v55, v128
    v_xor_b32 v129, v7, v129
    v_xor_b32 v130, v7, v130
    v_mfma_f32_32x32x16_bf16 v[88:103], v[180:183], v[40:43], v[88:103]
    v_or3_b32 v2, v2, v129, v130
    v_xor_b32 v131, v7, v131
    v_xor_b32 v132, v7, v132
    v_or3_b32 v2, v2, v131, v132
    v_xor_b32 v133, v7, v133
    v_mfma_f32_32x32x16_bf16 v[104:119], v[180:183], v[44:47], v[104:119]
    s_mul_i32 s3, s64, 23
    s_add_u32 m0, s67, 87040
    s_add_u32 s3, s3, s61
    buffer_load_dwordx4 v10, s[52:55], s3 offen sc1 lds
    v_xor_b32 v134, v7, v134
    v_or3_b32 v2, v2, v133, v134
    v_xor_b32 v135, v7, v135
    v_bitop3_b32 v2, v2, v135, s68 bitop3:0xa8
    v_cmp_ne_u32 vcc, 0, v2
    v_mfma_f32_32x32x16_bf16 v[56:71], v[176:179], v[40:43], v[56:71]
    s_waitcnt vmcnt(18)
    ds_read_b128 v[40:43], v6 offset:49152
    ds_read_b128 v[44:47], v6 offset:50176
    buffer_load_dwordx4 v[160:163], v8, s[40:43], s45 offen offset:0 sc1
    s_cbranch_vccnz L_hh8_retry
L_hh8_ok:
    v_mfma_f32_32x32x16_bf16 v[72:87], v[184:187], v[52:55], v[72:87]
    buffer_load_dwordx4 v[164:167], v9, s[40:43], s45 offen offset:0 sc1
    v_mfma_f32_32x32x16_bf16 v[88:103], v[188:191], v[48:51], v[88:103]
    buffer_load_dwordx4 v[168:171], v8, s[40:43], s46 offen offset:0 sc1
    s_waitcnt lgkmcnt(2)
    v_xor_b32 v32, v7, v32
    v_xor_b32 v33, v7, v33
    v_xor_b32 v34, v7, v34
    v_mfma_f32_32x32x16_bf16 v[104:119], v[188:191], v[52:55], v[104:119]
    buffer_load_dwordx4 v[172:175], v9, s[40:43], s46 offen offset:0 sc1
    v_or3_b32 v2, v32, v33, v34
    v_xor_b32 v35, v7, v35
    v_xor_b32 v36, v7, v36
    v_or3_b32 v2, v2, v35, v36
    v_mfma_f32_32x32x16_bf16 v[56:71], v[184:187], v[48:51], v[56:71]
    v_xor_b32 v37, v7, v37
    v_xor_b32 v38, v7, v38
    v_or3_b32 v2, v2, v37, v38
    v_xor_b32 v39, v7, v39
    s_waitcnt vmcnt(20)
    ds_read_b128 v[48:51], v6 offset:57344
    ds_read_b128 v[52:55], v6 offset:58368
    buffer_load_dwordx4 v[176:179], v8, s[40:43], s47 offen offset:0 sc1
    v_mfma_f32_32x32x16_bf16 v[72:87], v[192:195], v[132:135], v[72:87]
    buffer_load_dwordx4 v[180:183], v9, s[40:43], s47 offen offset:0 sc1
    s_waitcnt lgkmcnt(2)
    v_xor_b32 v40, v7, v40
    v_or3_b32 v2, v2, v39, v40
    v_xor_b32 v41, v7, v41
    v_xor_b32 v42, v7, v42
    v_mfma_f32_32x32x16_bf16 v[88:103], v[196:199], v[128:131], v[88:103]
    v_or3_b32 v2, v2, v41, v42
    v_xor_b32 v43, v7, v43
    v_xor_b32 v44, v7, v44
    v_or3_b32 v2, v2, v43, v44
    v_xor_b32 v45, v7, v45
    v_mfma_f32_32x32x16_bf16 v[104:119], v[196:199], v[132:135], v[104:119]
    buffer_load_dwordx4 v[184:187], v8, s[40:43], s44 offen offset:1024 sc1
    v_xor_b32 v46, v7, v46
    v_or3_b32 v2, v2, v45, v46
    v_xor_b32 v47, v7, v47
    v_bitop3_b32 v2, v2, v47, s68 bitop3:0xa8
    v_cmp_ne_u32 vcc, 0, v2
    v_mfma_f32_32x32x16_bf16 v[56:71], v[192:195], v[128:131], v[56:71]
    buffer_load_dwordx4 v[188:191], v9, s[40:43], s44 offen offset:1024 sc1
    s_cbranch_vccnz L_hh10_retry
L_hh10_ok:
    v_mfma_f32_32x32x16_bf16 v[72:87], v[200:203], v[36:39], v[72:87]
    buffer_load_dwordx4 v[128:131], v8, s[40:43], s45 offen offset:1024 sc1
    v_mfma_f32_32x32x16_bf16 v[88:103], v[204:207], v[32:35], v[88:103]
    buffer_load_dwordx4 v[132:135], v9, s[40:43], s45 offen offset:1024 sc1
    s_waitcnt lgkmcnt(0)
    v_xor_b32 v48, v7, v48
    v_xor_b32 v49, v7, v49
    v_xor_b32 v50, v7, v50
    v_mfma_f32_32x32x16_bf16 v[104:119], v[204:207], v[36:39], v[104:119]
    buffer_load_dwordx4 v[192:195], v8, s[40:43], s46 offen offset:1024 sc1
    v_or3_b32 v2, v48, v49, v50
    v_xor_b32 v51, v7, v51
    v_xor_b32 v52, v7, v52
    v_or3_b32 v2, v2, v51, v52
    v_mfma_f32_32x32x16_bf16 v[56:71], v[200:203], v[32:35], v[56:71]
    v_xor_b32 v53, v7, v53
    v_xor_b32 v54, v7, v54
    v_or3_b32 v2, v2, v53, v54
    v_xor_b32 v55, v7, v55
    buffer_load_dwordx4 v[196:199], v9, s[40:43], s46 offen offset:1024 sc1
    v_mfma_f32_32x32x16_bf16 v[72:87], v[208:211], v[44:47], v[72:87]
    buffer_load_dwordx4 v[32:35], v8, s[40:43], s47 offen offset:1024 sc1
    s_waitcnt vmcnt(27)
    v_xor_b32 v120, v7, v120
    v_or3_b32 v2, v2, v55, v120
    v_xor_b32 v121, v7, v121
    v_xor_b32 v122, v7, v122
    v_mfma_f32_32x32x16_bf16 v[88:103], v[212:215], v[40:43], v[88:103]
    v_or3_b32 v2, v2, v121, v122
    v_xor_b32 v123, v7, v123
    v_xor_b32 v124, v7, v124
    v_or3_b32 v2, v2, v123, v124
    v_xor_b32 v125, v7, v125
    v_mfma_f32_32x32x16_bf16 v[104:119], v[212:215], v[44:47], v[104:119]
    buffer_load_dwordx4 v[36:39], v9, s[40:43], s47 offen offset:1024 sc1
    v_xor_b32 v126, v7, v126
    v_or3_b32 v2, v2, v125, v126
    v_xor_b32 v127, v7, v127
    v_bitop3_b32 v2, v2, v127, s68 bitop3:0xa8
    v_cmp_ne_u32 vcc, 0, v2
    v_mfma_f32_32x32x16_bf16 v[56:71], v[208:211], v[40:43], v[56:71]
    s_cbranch_vccnz L_hh12_retry
L_hh12_ok:
    v_mfma_f32_32x32x16_bf16 v[72:87], v[216:219], v[52:55], v[72:87]
    v_mfma_f32_32x32x16_bf16 v[88:103], v[220:223], v[48:51], v[88:103]
    s_waitcnt vmcnt(26)
    v_xor_b32 v136, v7, v136
    v_xor_b32 v137, v7, v137
    v_xor_b32 v138, v7, v138
    v_mfma_f32_32x32x16_bf16 v[104:119], v[220:223], v[52:55], v[104:119]
    v_or3_b32 v2, v136, v137, v138
    v_xor_b32 v139, v7, v139
    v_xor_b32 v140, v7, v140
    v_or3_b32 v2, v2, v139, v140
    v_mfma_f32_32x32x16_bf16 v[56:71], v[216:219], v[48:51], v[56:71]
    v_xor_b32 v141, v7, v141
    v_xor_b32 v142, v7, v142
    v_or3_b32 v2, v2, v141, v142
    v_xor_b32 v143, v7, v143
    v_mfma_f32_32x32x16_bf16 v[72:87], v[224:227], v[124:127], v[72:87]
    s_waitcnt vmcnt(24)
    v_xor_b32 v144, v7, v144
    v_or3_b32 v2, v2, v143, v144
    v_xor_b32 v145, v7, v145
    v_xor_b32 v146, v7, v146
    v_mfma_f32_32x32x16_bf16 v[88:103], v[228:231], v[120:123], v[88:103]
    v_or3_b32 v2, v2, v145, v146
    v_xor_b32 v147, v7, v147
    v_xor_b32 v148, v7, v148
    v_or3_b32 v2, v2, v147, v148
    v_xor_b32 v149, v7, v149
    v_mfma_f32_32x32x16_bf16 v[104:119], v[228:231], v[124:127], v[104:119]
    v_xor_b32 v150, v7, v150
    v_or3_b32 v2, v2, v149, v150
    v_xor_b32 v151, v7, v151
    v_bitop3_b32 v2, v2, v151, s68 bitop3:0xa8
    v_cmp_ne_u32 vcc, 0, v2
    v_mfma_f32_32x32x16_bf16 v[56:71], v[224:227], v[120:123], v[56:71]
    s_cbranch_vccnz L_hh14_retry
L_hh14_ok:
    v_mfma_f32_32x32x16_bf16 v[72:87], v[232:235], v[140:143], v[72:87]
    v_mfma_f32_32x32x16_bf16 v[88:103], v[236:239], v[136:139], v[88:103]
    s_waitcnt vmcnt(22)
    v_xor_b32 v152, v7, v152
    v_xor_b32 v153, v7, v153
    v_xor_b32 v154, v7, v154
    v_mfma_f32_32x32x16_bf16 v[104:119], v[236:239], v[140:143], v[104:119]
    v_or3_b32 v2, v152, v153, v154
    v_xor_b32 v155, v7, v155
    v_xor_b32 v156, v7, v156
    v_or3_b32 v2, v2, v155, v156
    v_mfma_f32_32x32x16_bf16 v[56:71], v[232:235], v[136:139], v[56:71]
    v_xor_b32 v157, v7, v157
    v_xor_b32 v158, v7, v158
    v_or3_b32 v2, v2, v157, v158
    v_xor_b32 v159, v7, v159
    s_mov_b64 s[6:7], vcc
    v_mov_b32 v4, 0x27470
    s_branch L_gate5_t
L_gate5:
    s_add_u32 s0, s0, 1
    s_cmp_gt_u32 s0, 4194304
    s_cbranch_scc1 L_gate5_x
L_gate5_t:
    ds_read_b32 v5, v4
    s_waitcnt lgkmcnt(0)
    v_cmp_gt_u32 vcc, 64, v5
    s_cbranch_vccnz L_gate5
L_gate5_x:
    s_mov_b64 vcc, s[6:7]
    buffer_load_dwordx4 v[200:203], v8, s[40:43], s44 offen offset:2048 sc1
    v_mfma_f32_32x32x16_bf16 v[72:87], v[240:243], v[148:151], v[72:87]
    buffer_load_dwordx4 v[204:207], v9, s[40:43], s44 offen offset:2048 sc1
    s_waitcnt vmcnt(14)
    v_xor_b32 v160, v7, v160
    v_or3_b32 v2, v2, v159, v160
    v_xor_b32 v161, v7, v161
    v_xor_b32 v162, v7, v162
    v_mfma_f32_32x32x16_bf16 v[88:103], v[244:247], v[144:147], v[88:103]
    v_or3_b32 v2, v2, v161, v162
    v_xor_b32 v163, v7, v163
    v_xor_b32 v164, v7, v164
    v_or3_b32 v2, v2, v163, v164
    v_xor_b32 v165, v7, v165
    v_mfma_f32_32x32x16_bf16 v[104:119], v[244:247], v[148:151], v[104:119]
    buffer_load_dwordx4 v[40:43], v8, s[40:43], s45 offen offset:2048 sc1
    v_xor_b32 v166, v7, v166
    v_or3_b32 v2, v2, v165, v166
    v_xor_b32 v167, v7, v167
    v_bitop3_b32 v2, v2, v167, s68 bitop3:0xa8
    v_cmp_ne_u32 vcc, 0, v2
    v_mfma_f32_32x32x16_bf16 v[56:71], v[240:243], v[144:147], v[56:71]
    buffer_load_dwordx4 v[44:47], v9, s[40:43], s45 offen offset:2048 sc1
    s_cbranch_vccnz L_hh16_retry
L_hh16_ok:
    v_mfma_f32_32x32x16_bf16 v[72:87], v[248:251], v[156:159], v[72:87]
    ds_read_b64_tr_b16 v[24:25], v11 offset:0
    ds_read_b64_tr_b16 v[26:27], v11 offset:512
    ds_read_b64_tr_b16 v[28:29], v12 offset:0
    ds_read_b64_tr_b16 v[30:31], v12 offset:512
    buffer_load_dwordx4 v[208:211], v8, s[40:43], s46 offen offset:2048 sc1
    v_mfma_f32_32x32x16_bf16 v[88:103], v[252:255], v[152:155], v[88:103]
    buffer_load_dwordx4 v[212:215], v9, s[40:43], s46 offen offset:2048 sc1
    s_waitcnt vmcnt(16)
    v_xor_b32 v168, v7, v168
    v_xor_b32 v169, v7, v169
    v_xor_b32 v170, v7, v170
    v_mfma_f32_32x32x16_bf16 v[104:119], v[252:255], v[156:159], v[104:119]
    buffer_load_dwordx4 v[48:51], v8, s[40:43], s47 offen offset:2048 sc1
    v_or3_b32 v2, v168, v169, v170
    v_xor_b32 v171, v7, v171
    v_xor_b32 v172, v7, v172
    v_or3_b32 v2, v2, v171, v172
    v_mfma_f32_32x32x16_bf16 v[56:71], v[248:251], v[152:155], v[56:71]
    v_xor_b32 v173, v7, v173
    v_xor_b32 v174, v7, v174
    v_or3_b32 v2, v2, v173, v174
    v_xor_b32 v175, v7, v175
    buffer_load_dwordx4 v[52:55], v9, s[40:43], s47 offen offset:2048 sc1
    s_waitcnt lgkmcnt(0)
    v_mfma_f32_32x32x16_bf16 v[72:87], v[24:27], v[164:167], v[72:87]
    ds_read_b64_tr_b16 v[16:17], v11 offset:8192
    ds_read_b64_tr_b16 v[18:19], v11 offset:8704
    ds_read_b64_tr_b16 v[20:21], v12 offset:8192
    ds_read_b64_tr_b16 v[22:23], v12 offset:8704
    v_and_b32 v6, 7, v1
    v_lshlrev_b32 v6, 15, v6
    v_lshrrev_b32 v5, 3, v1
    v_lshl_add_u32 v6, v5, 2, v6
    s_lshl_b32 s62, s65, 1
    s_and_b32 s3, s66, 1
    s_add_u32 s62, s62, s3
    s_lshl_b32 s62, s62, 8
    s_lshl_b32 s3, s4, 5
    s_add_u32 s62, s62, s3
    s_lshr_b32 s3, s66, 1
    s_xor_b32 s3, s3, 1
    s_lshl_b32 s3, s3, 18
    s_add_u32 s62, s62, s3
    s_add_u32 s62, s62, 0x400000
    s_add_u32 s3, s62, 0
    buffer_load_dword v248, v6, s[40:43], s3 offen sc1
    s_waitcnt vmcnt(17)
    v_xor_b32 v176, v7, v176
    v_or3_b32 v2, v2, v175, v176
    v_xor_b32 v177, v7, v177
    v_xor_b32 v178, v7, v178
    v_mfma_f32_32x32x16_bf16 v[88:103], v[28:31], v[160:163], v[88:103]
    v_or3_b32 v2, v2, v177, v178
    v_xor_b32 v179, v7, v179
    v_xor_b32 v180, v7, v180
    v_or3_b32 v2, v2, v179, v180
    v_xor_b32 v181, v7, v181
    v_mfma_f32_32x32x16_bf16 v[104:119], v[28:31], v[164:167], v[104:119]
    s_add_u32 s3, s62, 8192
    buffer_load_dword v249, v6, s[40:43], s3 offen sc1
    v_xor_b32 v182, v7, v182
    v_or3_b32 v2, v2, v181, v182
    v_xor_b32 v183, v7, v183
    v_bitop3_b32 v2, v2, v183, s68 bitop3:0xa8
    v_cmp_ne_u32 vcc, 0, v2
    v_mfma_f32_32x32x16_bf16 v[56:71], v[24:27], v[160:163], v[56:71]
    s_add_u32 s3, s62, 16384
    buffer_load_dword v250, v6, s[40:43], s3 offen sc1
    s_cbranch_vccnz L_hh18_retry
L_hh18_ok:
    s_waitcnt lgkmcnt(0)
    v_mfma_f32_32x32x16_bf16 v[72:87], v[16:19], v[172:175], v[72:87]
    ds_read_b64_tr_b16 v[24:25], v11 offset:16384
    ds_read_b64_tr_b16 v[26:27], v11 offset:16896
    ds_read_b64_tr_b16 v[28:29], v12 offset:16384
    ds_read_b64_tr_b16 v[30:31], v12 offset:16896
    s_add_u32 s3, s62, 24576
    buffer_load_dword v251, v6, s[40:43], s3 offen sc1
    v_mfma_f32_32x32x16_bf16 v[88:103], v[20:23], v[168:171], v[88:103]
    s_waitcnt vmcnt(18)
    v_xor_b32 v184, v7, v184
    v_xor_b32 v185, v7, v185
    v_xor_b32 v186, v7, v186
    v_mfma_f32_32x32x16_bf16 v[104:119], v[20:23], v[172:175], v[104:119]
    v_or3_b32 v2, v184, v185, v186
    v_xor_b32 v187, v7, v187
    v_xor_b32 v188, v7, v188
    v_or3_b32 v2, v2, v187, v188
    v_mfma_f32_32x32x16_bf16 v[56:71], v[16:19], v[168:171], v[56:71]
    v_xor_b32 v189, v7, v189
    v_xor_b32 v190, v7, v190
    v_or3_b32 v2, v2, v189, v190
    v_xor_b32 v191, v7, v191
    s_waitcnt lgkmcnt(0)
    v_mfma_f32_32x32x16_bf16 v[72:87], v[24:27], v[180:183], v[72:87]
    ds_read_b64_tr_b16 v[16:17], v11 offset:24576
    ds_read_b64_tr_b16 v[18:19], v11 offset:25088
    ds_read_b64_tr_b16 v[20:21], v12 offset:24576
    ds_read_b64_tr_b16 v[22:23], v12 offset:25088
    s_waitcnt vmcnt(16)
    v_xor_b32 v128, v7, v128
    v_or3_b32 v2, v2, v191, v128
    v_xor_b32 v129, v7, v129
    v_xor_b32 v130, v7, v130
    v_mfma_f32_32x32x16_bf16 v[88:103], v[28:31], v[176:179], v[88:103]
    v_or3_b32 v2, v2, v129, v130
    v_xor_b32 v131, v7, v131
    v_xor_b32 v132, v7, v132
    v_or3_b32 v2, v2, v131, v132
    v_xor_b32 v133, v7, v133
    v_mfma_f32_32x32x16_bf16 v[104:119], v[28:31], v[180:183], v[104:119]
    v_xor_b32 v134, v7, v134
    v_or3_b32 v2, v2, v133, v134
    v_xor_b32 v135, v7, v135
    v_bitop3_b32 v2, v2, v135, s68 bitop3:0xa8
    v_cmp_ne_u32 vcc, 0, v2
    v_mfma_f32_32x32x16_bf16 v[56:71], v[24:27], v[176:179], v[56:71]
    s_cbranch_vccnz L_hh20_retry
L_hh20_ok:
    s_waitcnt lgkmcnt(0)
    v_mfma_f32_32x32x16_bf16 v[72:87], v[16:19], v[188:191], v[72:87]
    ds_read_b64_tr_b16 v[24:25], v11 offset:32768
    ds_read_b64_tr_b16 v[26:27], v11 offset:33280
    ds_read_b64_tr_b16 v[28:29], v12 offset:32768
    ds_read_b64_tr_b16 v[30:31], v12 offset:33280
    v_mfma_f32_32x32x16_bf16 v[88:103], v[20:23], v[184:187], v[88:103]
    s_waitcnt vmcnt(14)
    v_xor_b32 v192, v7, v192
    v_xor_b32 v193, v7, v193
    v_xor_b32 v194, v7, v194
    v_mfma_f32_32x32x16_bf16 v[104:119], v[20:23], v[188:191], v[104:119]
    v_or3_b32 v2, v192, v193, v194
    v_xor_b32 v195, v7, v195
    v_xor_b32 v196, v7, v196
    v_or3_b32 v2, v2, v195, v196
    v_mfma_f32_32x32x16_bf16 v[56:71], v[16:19], v[184:187], v[56:71]
    v_xor_b32 v197, v7, v197
    v_xor_b32 v198, v7, v198
    v_or3_b32 v2, v2, v197, v198
    v_xor_b32 v199, v7, v199
    s_waitcnt lgkmcnt(0)
    v_mfma_f32_32x32x16_bf16 v[72:87], v[24:27], v[132:135], v[72:87]
    ds_read_b64_tr_b16 v[16:17], v11 offset:40960
    ds_read_b64_tr_b16 v[18:19], v11 offset:41472
    ds_read_b64_tr_b16 v[20:21], v12 offset:40960
    ds_read_b64_tr_b16 v[22:23], v12 offset:41472
    s_waitcnt vmcnt(12)
    v_xor_b32 v32, v7, v32
    v_or3_b32 v2, v2, v199, v32
    v_xor_b32 v33, v7, v33
    v_xor_b32 v34, v7, v34
    v_mfma_f32_32x32x16_bf16 v[88:103], v[28:31], v[128:131], v[88:103]
    v_or3_b32 v2, v2, v33, v34
    v_xor_b32 v35, v7, v35
    v_xor_b32 v36, v7, v36
    v_or3_b32 v2, v2, v35, v36
    v_xor_b32 v37, v7, v37
    v_mfma_f32_32x32x16_bf16 v[104:119], v[28:31], v[132:135], v[104:119]
    v_xor_b32 v38, v7, v38
    v_or3_b32 v2, v2, v37, v38
    v_xor_b32 v39, v7, v39
    v_bitop3_b32 v2, v2, v39, s68 bitop3:0xa8
    v_cmp_ne_u32 vcc, 0, v2
    v_mfma_f32_32x32x16_bf16 v[56:71], v[24:27], v[128:131], v[56:71]
    s_cbranch_vccnz L_hh22_retry
L_hh22_ok:
    s_waitcnt lgkmcnt(0)
    v_mfma_f32_32x32x16_bf16 v[72:87], v[16:19], v[196:199], v[72:87]
    ds_read_b64_tr_b16 v[24:25], v11 offset:49152
    ds_read_b64_tr_b16 v[26:27], v11 offset:49664
    ds_read_b64_tr_b16 v[28:29], v12 offset:49152
    ds_read_b64_tr_b16 v[30:31], v12 offset:49664
    v_mfma_f32_32x32x16_bf16 v[88:103], v[20:23], v[192:195], v[88:103]
    s_waitcnt vmcnt(10)
    v_xor_b32 v200, v7, v200
    v_xor_b32 v201, v7, v201
    v_xor_b32 v202, v7, v202
    v_mfma_f32_32x32x16_bf16 v[104:119], v[20:23], v[196:199], v[104:119]
    v_or3_b32 v2, v200, v201, v202
    v_xor_b32 v203, v7, v203
    v_xor_b32 v204, v7, v204
    v_or3_b32 v2, v2, v203, v204
    v_mfma_f32_32x32x16_bf16 v[56:71], v[16:19], v[192:195], v[56:71]
    v_xor_b32 v205, v7, v205
    v_xor_b32 v206, v7, v206
    v_or3_b32 v2, v2, v205, v206
    v_xor_b32 v207, v7, v207
    s_waitcnt lgkmcnt(0)
    v_mfma_f32_32x32x16_bf16 v[72:87], v[24:27], v[36:39], v[72:87]
    ds_read_b64_tr_b16 v[16:17], v11 offset:61440
    ds_read_b64_tr_b16 v[18:19], v11 offset:61952
    ds_read_b64_tr_b16 v[20:21], v12 offset:61440
    ds_read_b64_tr_b16 v[22:23], v12 offset:61952
    s_waitcnt vmcnt(8)
    v_xor_b32 v40, v7, v40
    v_or3_b32 v2, v2, v207, v40
    v_xor_b32 v41, v7, v41
    v_xor_b32 v42, v7, v42
    v_mfma_f32_32x32x16_bf16 v[88:103], v[28:31], v[32:35], v[88:103]
    v_or3_b32 v2, v2, v41, v42
    v_xor_b32 v43, v7, v43
    v_xor_b32 v44, v7, v44
    v_or3_b32 v2, v2, v43, v44
    v_xor_b32 v45, v7, v45
    v_mfma_f32_32x32x16_bf16 v[104:119], v[28:31], v[36:39], v[104:119]
    v_xor_b32 v46, v7, v46
    v_or3_b32 v2, v2, v45, v46
    v_xor_b32 v47, v7, v47
    v_bitop3_b32 v2, v2, v47, s68 bitop3:0xa8
    v_cmp_ne_u32 vcc, 0, v2
    v_mfma_f32_32x32x16_bf16 v[56:71], v[24:27], v[32:35], v[56:71]
    s_cbranch_vccnz L_hh24_retry
L_hh24_ok:
    s_waitcnt lgkmcnt(0)
    v_mfma_f32_32x32x16_bf16 v[72:87], v[16:19], v[204:207], v[72:87]
    ds_read_b64_tr_b16 v[24:25], v13 offset:4096
    ds_read_b64_tr_b16 v[26:27], v13 offset:4608
    ds_read_b64_tr_b16 v[28:29], v14 offset:4096
    ds_read_b64_tr_b16 v[30:31], v14 offset:4608
    v_mfma_f32_32x32x16_bf16 v[88:103], v[20:23], v[200:203], v[88:103]
    s_waitcnt vmcnt(6)
    v_xor_b32 v208, v7, v208
    v_xor_b32 v209, v7, v209
    v_xor_b32 v210, v7, v210
    v_mfma_f32_32x32x16_bf16 v[104:119], v[20:23], v[204:207], v[104:119]
    v_or3_b32 v2, v208, v209, v210
    v_xor_b32 v211, v7, v211
    v_xor_b32 v212, v7, v212
    v_or3_b32 v2, v2, v211, v212
    v_mfma_f32_32x32x16_bf16 v[56:71], v[16:19], v[200:203], v[56:71]
    v_xor_b32 v213, v7, v213
    v_xor_b32 v214, v7, v214
    v_or3_b32 v2, v2, v213, v214
    v_xor_b32 v215, v7, v215
    s_waitcnt lgkmcnt(0)
    v_mfma_f32_32x32x16_bf16 v[72:87], v[24:27], v[44:47], v[72:87]
    ds_read_b64_tr_b16 v[16:17], v13 offset:12288
    ds_read_b64_tr_b16 v[18:19], v13 offset:12800
    ds_read_b64_tr_b16 v[20:21], v14 offset:12288
    ds_read_b64_tr_b16 v[22:23], v14 offset:12800
    s_waitcnt vmcnt(4)
    v_xor_b32 v48, v7, v48
    v_or3_b32 v2, v2, v215, v48
    v_xor_b32 v49, v7, v49
    v_xor_b32 v50, v7, v50
    v_mfma_f32_32x32x16_bf16 v[88:103], v[28:31], v[40:43], v[88:103]
    v_or3_b32 v2, v2, v49, v50
    v_xor_b32 v51, v7, v51
    v_xor_b32 v52, v7, v52
    v_or3_b32 v2, v2, v51, v52
    v_xor_b32 v53, v7, v53
    v_mfma_f32_32x32x16_bf16 v[104:119], v[28:31], v[44:47], v[104:119]
    v_xor_b32 v54, v7, v54
    v_or3_b32 v2, v2, v53, v54
    v_xor_b32 v55, v7, v55
    v_bitop3_b32 v2, v2, v55, s68 bitop3:0xa8
    v_cmp_ne_u32 vcc, 0, v2
    v_mfma_f32_32x32x16_bf16 v[56:71], v[24:27], v[40:43], v[56:71]
    s_cbranch_vccnz L_hh26_retry
L_hh26_ok:
    ds_read_b64_tr_b16 v[24:25], v13 offset:20480
    ds_read_b64_tr_b16 v[26:27], v13 offset:20992
    ds_read_b64_tr_b16 v[28:29], v14 offset:20480
    ds_read_b64_tr_b16 v[30:31], v14 offset:20992
    s_waitcnt vmcnt(0)
    s_waitcnt lgkmcnt(4)
    v_mfma_f32_32x32x16_bf16 v[72:87], v[16:19], v[212:215], v[72:87]
    v_lshrrev_b32 v2, 5, v1
    v_lshlrev_b32 v2, 6, v2
    v_xor_b32 v10, v15, v2
    v_add_u32 v10, 0x17000, v10
    v_xor_b32 v11, 32, v10
    s_waitcnt lgkmcnt(0)
    v_mfma_f32_32x32x16_bf16 v[72:87], v[24:27], v[52:55], v[72:87]
    v_xor_b32 v12, 128, v10
    v_xor_b32 v13, 160, v10
    v_lshrrev_b32 v3, 3, v1
    s_and_b32 s3, s4, 3
    v_lshl_add_u32 v3, s3, 3, v3
    v_mfma_f32_32x32x16_bf16 v[88:103], v[20:23], v[208:211], v[88:103]
    v_bfe_u32 v4, v1, 1, 1
    v_lshl_add_u32 v2, v4, 5, v3
    v_lshlrev_b32 v2, 4, v2
    v_and_b32 v4, 7, v1
    v_lshlrev_b32 v5, 5, v4
    v_mfma_f32_32x32x16_bf16 v[88:103], v[28:31], v[48:51], v[88:103]
    v_xor_b32 v2, v2, v5
    v_bfe_u32 v5, v1, 2, 1
    v_lshl_add_u32 v2, v5, 15, v2
    v_and_b32 v5, 1, v1
    v_lshl_add_u32 v2, v5, 13, v2
    v_mfma_f32_32x32x16_bf16 v[104:119], v[20:23], v[212:215], v[104:119]
    ds_write_b128 v10, v[72:75] offset:16384
    s_lshr_b32 s57, s4, 2
    s_lshl_b32 s3, s57, 14
    v_mfma_f32_32x32x16_bf16 v[104:119], v[28:31], v[52:55], v[104:119]
    ds_write_b128 v10, v[76:79] offset:17408
    s_add_u32 s3, s3, 94208
    v_add_u32 v2, s3, v2
    v_mfma_f32_32x32x16_bf16 v[56:71], v[16:19], v[208:211], v[56:71]
    ds_write_b128 v11, v[80:83] offset:24576
    s_lshl_b32 s3, s57, 7
    s_add_u32 s3, s3, 161792
    v_mfma_f32_32x32x16_bf16 v[56:71], v[24:27], v[48:51], v[56:71]
    ds_write_b128 v11, v[84:87] offset:25600
    v_lshl_add_u32 v8, v3, 2, s3
    v_lshrrev_b32 v9, 2, v3
    ds_write_b128 v12, v[88:91] offset:32768
    v_lshlrev_b32 v9, 13, v9
    v_and_b32 v5, 3, v3
    v_lshl_add_u32 v9, v5, 10, v9
    ds_write_b128 v12, v[92:95] offset:33792
    v_lshl_add_u32 v9, v4, 4, v9
    s_lshl_b32 s58, s65, 1
    s_and_b32 s3, s66, 1
    ds_write_b128 v13, v[96:99] offset:40960
    s_add_u32 s58, s58, s3
    s_lshl_b32 s58, s58, 16
    s_lshl_b32 s3, s57, 12
    ds_write_b128 v13, v[100:103] offset:41984
    s_add_u32 s58, s58, s3
    s_lshr_b32 s3, s66, 1
    s_xor_b32 s3, s3, 1
    ds_write_b128 v12, v[104:107] offset:49152
    s_lshl_b32 s3, s3, 7
    s_add_u32 s58, s58, s3
    v_lshlrev_b32 v40, 16, v248
    ds_write_b128 v12, v[108:111] offset:50176
    v_and_b32 v41, s59, v248
    v_lshlrev_b32 v42, 16, v249
    v_and_b32 v43, s59, v249
    ds_write_b128 v13, v[112:115] offset:57344
    v_lshlrev_b32 v44, 16, v250
    v_and_b32 v45, s59, v250
    v_lshlrev_b32 v46, 16, v251
    ds_write_b128 v13, v[116:119] offset:58368
    v_and_b32 v47, s59, v251
    ds_write_b128 v10, v[56:59] offset:0
    ds_write_b128 v10, v[60:63] offset:1024
    ds_write_b128 v11, v[64:67] offset:8192
    ds_write_b128 v11, v[68:71] offset:9216
    s_mov_b32 s44, s34
    s_and_b32 s45, s35, 0xffff
    s_mov_b32 s46, 0x200000
    s_mov_b32 s47, 0x20000
    s_waitcnt lgkmcnt(0)
    s_barrier
    ds_read_b32 v12, v8
    ds_read_b128 v[128:131], v2 offset:0
    ds_read_b128 v[132:135], v2 offset:1024
    ds_read_b128 v[136:139], v2 offset:2048
    ds_read_b128 v[140:143], v2 offset:3072
    ds_read_b128 v[144:147], v2 offset:4096
    ds_read_b128 v[148:151], v2 offset:5120
    ds_read_b128 v[152:155], v2 offset:6144
    ds_read_b128 v[156:159], v2 offset:7168
    s_waitcnt lgkmcnt(4)
    v_pk_add_f32 v[128:129], v[128:129], v[136:137]
    v_pk_add_f32 v[130:131], v[130:131], v[138:139]
    v_pk_add_f32 v[132:133], v[132:133], v[140:141]
    v_pk_add_f32 v[134:135], v[134:135], v[142:143]
    s_waitcnt lgkmcnt(2)
    v_pk_add_f32 v[128:129], v[128:129], v[144:145]
    v_pk_add_f32 v[130:131], v[130:131], v[146:147]
    v_pk_add_f32 v[132:133], v[132:133], v[148:149]
    v_pk_add_f32 v[134:135], v[134:135], v[150:151]
    s_waitcnt lgkmcnt(0)
    v_pk_add_f32 v[128:129], v[128:129], v[152:153]
    v_pk_add_f32 v[130:131], v[130:131], v[154:155]
    v_pk_add_f32 v[132:133], v[132:133], v[156:157]
    v_pk_add_f32 v[134:135], v[134:135], v[158:159]
    v_pk_fma_f32 v[128:129], v[128:129], v[12:13], v[40:41] op_sel_hi:[1,0,1]
    v_pk_fma_f32 v[130:131], v[130:131], v[12:13], v[42:43] op_sel_hi:[1,0,1]
    v_pk_fma_f32 v[132:133], v[132:133], v[12:13], v[44:45] op_sel_hi:[1,0,1]
    v_pk_fma_f32 v[134:135], v[134:135], v[12:13], v[46:47] op_sel_hi:[1,0,1]
    v_cvt_pk_bf16_f32 v16, v128, v129
    v_cvt_pk_bf16_f32 v17, v130, v131
    v_cvt_pk_bf16_f32 v18, v132, v133
    v_cvt_pk_bf16_f32 v19, v134, v135
    buffer_store_dwordx4 v[16:19], v9, s[44:47], s58 offen sc1
    s_endpgm
L_w_p2:
    ds_read_b32 v0, v14 offset:1084
    s_add_u32 s0, s0, 1
    s_waitcnt lgkmcnt(0)
    v_readfirstlane_b32 s58, v0
    s_nop 1
    s_cmp_ge_u32 s58, 4
    s_cbranch_scc1 L_w_p2_ok
    s_cmp_lt_u32 s0, 4194304
    s_cbranch_scc1 L_w_p2
    s_branch L_w_p2_ok
L_tk0_retry:
    s_add_u32 s69, s69, 1
    s_cmp_gt_u32 s69, 262144
    s_cbranch_scc1 L_tk0_ok
    v_and_b32 v12, 15, v1
    v_lshlrev_b32 v12, 2, v12
    v_lshrrev_b32 v13, 4, v1
    v_lshl_add_u32 v12, v13, 15, v12
    s_add_u32 s3, s64, 0
    buffer_load_dword v128, v12, s[40:43], s3 offen sc1
    s_add_u32 s3, s64, 8192
    buffer_load_dword v129, v12, s[40:43], s3 offen sc1
    s_add_u32 s3, s64, 16384
    buffer_load_dword v130, v12, s[40:43], s3 offen sc1
    s_add_u32 s3, s64, 24576
    buffer_load_dword v131, v12, s[40:43], s3 offen sc1
    s_add_u32 s3, s64, 64
    buffer_load_dword v132, v12, s[40:43], s3 offen sc1
    s_add_u32 s3, s64, 8256
    buffer_load_dword v133, v12, s[40:43], s3 offen sc1
    s_add_u32 s3, s64, 16448
    buffer_load_dword v134, v12, s[40:43], s3 offen sc1
    s_add_u32 s3, s64, 24640
    buffer_load_dword v135, v12, s[40:43], s3 offen sc1
    s_add_u32 s3, s64, 131072
    buffer_load_dword v136, v12, s[40:43], s3 offen sc1
    s_add_u32 s3, s64, 139264
    buffer_load_dword v137, v12, s[40:43], s3 offen sc1
    s_add_u32 s3, s64, 147456
    buffer_load_dword v138, v12, s[40:43], s3 offen sc1
    s_add_u32 s3, s64, 155648
    buffer_load_dword v139, v12, s[40:43], s3 offen sc1
    s_add_u32 s3, s64, 131136
    buffer_load_dword v140, v12, s[40:43], s3 offen sc1
    s_add_u32 s3, s64, 139328
    buffer_load_dword v141, v12, s[40:43], s3 offen sc1
    s_add_u32 s3, s64, 147520
    buffer_load_dword v142, v12, s[40:43], s3 offen sc1
    s_add_u32 s3, s64, 155712
    buffer_load_dword v143, v12, s[40:43], s3 offen sc1
    s_waitcnt vmcnt(0)
    v_max3_u32 v12, v128, v129, v130
    v_max3_u32 v13, v131, v132, v133
    v_max3_u32 v12, v12, v134, v135
    v_max3_u32 v13, v13, v136, v137
    v_max3_u32 v12, v12, v138, v139
    v_max3_u32 v13, v13, v140, v141
    v_max3_u32 v12, v12, v142, v143
    v_max_u32 v12, v12, v13
    v_cmp_eq_u32 vcc, -1, v12
    s_cbranch_vccnz L_tk0_retry
    s_branch L_tk0_ok
L_tk1_retry:
    s_add_u32 s69, s69, 1
    s_cmp_gt_u32 s69, 262144
    s_cbranch_scc1 L_tk1_ok
    v_and_b32 v12, 15, v1
    v_lshlrev_b32 v12, 2, v12
    v_lshrrev_b32 v13, 4, v1
    v_lshl_add_u32 v12, v13, 15, v12
    s_add_u32 s3, s64, 262144
    buffer_load_dword v144, v12, s[40:43], s3 offen sc1
    s_add_u32 s3, s64, 270336
    buffer_load_dword v145, v12, s[40:43], s3 offen sc1
    s_add_u32 s3, s64, 278528
    buffer_load_dword v146, v12, s[40:43], s3 offen sc1
    s_add_u32 s3, s64, 286720
    buffer_load_dword v147, v12, s[40:43], s3 offen sc1
    s_add_u32 s3, s64, 262208
    buffer_load_dword v148, v12, s[40:43], s3 offen sc1
    s_add_u32 s3, s64, 270400
    buffer_load_dword v149, v12, s[40:43], s3 offen sc1
    s_add_u32 s3, s64, 278592
    buffer_load_dword v150, v12, s[40:43], s3 offen sc1
    s_add_u32 s3, s64, 286784
    buffer_load_dword v151, v12, s[40:43], s3 offen sc1
    s_add_u32 s3, s64, 393216
    buffer_load_dword v152, v12, s[40:43], s3 offen sc1
    s_add_u32 s3, s64, 401408
    buffer_load_dword v153, v12, s[40:43], s3 offen sc1
    s_add_u32 s3, s64, 409600
    buffer_load_dword v154, v12, s[40:43], s3 offen sc1
    s_add_u32 s3, s64, 417792
    buffer_load_dword v155, v12, s[40:43], s3 offen sc1
    s_add_u32 s3, s64, 393280
    buffer_load_dword v156, v12, s[40:43], s3 offen sc1
    s_add_u32 s3, s64, 401472
    buffer_load_dword v157, v12, s[40:43], s3 offen sc1
    s_add_u32 s3, s64, 409664
    buffer_load_dword v158, v12, s[40:43], s3 offen sc1
    s_add_u32 s3, s64, 417856
    buffer_load_dword v159, v12, s[40:43], s3 offen sc1
    s_waitcnt vmcnt(0)
    v_max3_u32 v12, v144, v145, v146
    v_max3_u32 v13, v147, v148, v149
    v_max3_u32 v12, v12, v150, v151
    v_max3_u32 v13, v13, v152, v153
    v_max3_u32 v12, v12, v154, v155
    v_max3_u32 v13, v13, v156, v157
    v_max3_u32 v12, v12, v158, v159
    v_max_u32 v12, v12, v13
    v_cmp_eq_u32 vcc, -1, v12
    s_cbranch_vccnz L_tk1_retry
    s_branch L_tk1_ok
L_tk2_retry:
    s_add_u32 s69, s69, 1
    s_cmp_gt_u32 s69, 262144
    s_cbranch_scc1 L_tk2_ok
    v_and_b32 v12, 15, v1
    v_lshlrev_b32 v12, 2, v12
    v_lshrrev_b32 v13, 4, v1
    v_lshl_add_u32 v12, v13, 15, v12
    s_add_u32 s3, s64, 524288
    buffer_load_dword v160, v12, s[40:43], s3 offen sc1
    s_add_u32 s3, s64, 532480
    buffer_load_dword v161, v12, s[40:43], s3 offen sc1
    s_add_u32 s3, s64, 540672
    buffer_load_dword v162, v12, s[40:43], s3 offen sc1
    s_add_u32 s3, s64, 548864
    buffer_load_dword v163, v12, s[40:43], s3 offen sc1
    s_add_u32 s3, s64, 524352
    buffer_load_dword v164, v12, s[40:43], s3 offen sc1
    s_add_u32 s3, s64, 532544
    buffer_load_dword v165, v12, s[40:43], s3 offen sc1
    s_add_u32 s3, s64, 540736
    buffer_load_dword v166, v12, s[40:43], s3 offen sc1
    s_add_u32 s3, s64, 548928
    buffer_load_dword v167, v12, s[40:43], s3 offen sc1
    s_add_u32 s3, s64, 655360
    buffer_load_dword v168, v12, s[40:43], s3 offen sc1
    s_add_u32 s3, s64, 663552
    buffer_load_dword v169, v12, s[40:43], s3 offen sc1
    s_add_u32 s3, s64, 671744
    buffer_load_dword v170, v12, s[40:43], s3 offen sc1
    s_add_u32 s3, s64, 679936
    buffer_load_dword v171, v12, s[40:43], s3 offen sc1
    s_add_u32 s3, s64, 655424
    buffer_load_dword v172, v12, s[40:43], s3 offen sc1
    s_add_u32 s3, s64, 663616
    buffer_load_dword v173, v12, s[40:43], s3 offen sc1
    s_add_u32 s3, s64, 671808
    buffer_load_dword v174, v12, s[40:43], s3 offen sc1
    s_add_u32 s3, s64, 680000
    buffer_load_dword v175, v12, s[40:43], s3 offen sc1
    s_waitcnt vmcnt(0)
    v_max3_u32 v12, v160, v161, v162
    v_max3_u32 v13, v163, v164, v165
    v_max3_u32 v12, v12, v166, v167
    v_max3_u32 v13, v13, v168, v169
    v_max3_u32 v12, v12, v170, v171
    v_max3_u32 v13, v13, v172, v173
    v_max3_u32 v12, v12, v174, v175
    v_max_u32 v12, v12, v13
    v_cmp_eq_u32 vcc, -1, v12
    s_cbranch_vccnz L_tk2_retry
    s_branch L_tk2_ok
L_tk3_retry:
    s_add_u32 s69, s69, 1
    s_cmp_gt_u32 s69, 262144
    s_cbranch_scc1 L_tk3_ok
    v_and_b32 v12, 15, v1
    v_lshlrev_b32 v12, 2, v12
    v_lshrrev_b32 v13, 4, v1
    v_lshl_add_u32 v12, v13, 15, v12
    s_add_u32 s3, s64, 786432
    buffer_load_dword v176, v12, s[40:43], s3 offen sc1
    s_add_u32 s3, s64, 794624
    buffer_load_dword v177, v12, s[40:43], s3 offen sc1
    s_add_u32 s3, s64, 802816
    buffer_load_dword v178, v12, s[40:43], s3 offen sc1
    s_add_u32 s3, s64, 811008
    buffer_load_dword v179, v12, s[40:43], s3 offen sc1
    s_add_u32 s3, s64, 786496
    buffer_load_dword v180, v12, s[40:43], s3 offen sc1
    s_add_u32 s3, s64, 794688
    buffer_load_dword v181, v12, s[40:43], s3 offen sc1
    s_add_u32 s3, s64, 802880
    buffer_load_dword v182, v12, s[40:43], s3 offen sc1
    s_add_u32 s3, s64, 811072
    buffer_load_dword v183, v12, s[40:43], s3 offen sc1
    s_add_u32 s3, s64, 917504
    buffer_load_dword v184, v12, s[40:43], s3 offen sc1
    s_add_u32 s3, s64, 925696
    buffer_load_dword v185, v12, s[40:43], s3 offen sc1
    s_add_u32 s3, s64, 933888
    buffer_load_dword v186, v12, s[40:43], s3 offen sc1
    s_add_u32 s3, s64, 942080
    buffer_load_dword v187, v12, s[40:43], s3 offen sc1
    s_add_u32 s3, s64, 917568
    buffer_load_dword v188, v12, s[40:43], s3 offen sc1
    s_add_u32 s3, s64, 925760
    buffer_load_dword v189, v12, s[40:43], s3 offen sc1
    s_add_u32 s3, s64, 933952
    buffer_load_dword v190, v12, s[40:43], s3 offen sc1
    s_add_u32 s3, s64, 942144
    buffer_load_dword v191, v12, s[40:43], s3 offen sc1
    s_waitcnt vmcnt(0)
    v_max3_u32 v12, v176, v177, v178
    v_max3_u32 v13, v179, v180, v181
    v_max3_u32 v12, v12, v182, v183
    v_max3_u32 v13, v13, v184, v185
    v_max3_u32 v12, v12, v186, v187
    v_max3_u32 v13, v13, v188, v189
    v_max3_u32 v12, v12, v190, v191
    v_max_u32 v12, v12, v13
    v_cmp_eq_u32 vcc, -1, v12
    s_cbranch_vccnz L_tk3_retry
    s_branch L_tk3_ok
L_tk4_retry:
    s_add_u32 s69, s69, 1
    s_cmp_gt_u32 s69, 262144
    s_cbranch_scc1 L_tk4_ok
    v_and_b32 v12, 15, v1
    v_lshlrev_b32 v12, 2, v12
    v_lshrrev_b32 v13, 4, v1
    v_lshl_add_u32 v12, v13, 15, v12
    s_add_u32 s3, s64, 1048576
    buffer_load_dword v192, v12, s[40:43], s3 offen sc1
    s_add_u32 s3, s64, 1056768
    buffer_load_dword v193, v12, s[40:43], s3 offen sc1
    s_add_u32 s3, s64, 1064960
    buffer_load_dword v194, v12, s[40:43], s3 offen sc1
    s_add_u32 s3, s64, 1073152
    buffer_load_dword v195, v12, s[40:43], s3 offen sc1
    s_add_u32 s3, s64, 1048640
    buffer_load_dword v196, v12, s[40:43], s3 offen sc1
    s_add_u32 s3, s64, 1056832
    buffer_load_dword v197, v12, s[40:43], s3 offen sc1
    s_add_u32 s3, s64, 1065024
    buffer_load_dword v198, v12, s[40:43], s3 offen sc1
    s_add_u32 s3, s64, 1073216
    buffer_load_dword v199, v12, s[40:43], s3 offen sc1
    s_add_u32 s3, s64, 1179648
    buffer_load_dword v200, v12, s[40:43], s3 offen sc1
    s_add_u32 s3, s64, 1187840
    buffer_load_dword v201, v12, s[40:43], s3 offen sc1
    s_add_u32 s3, s64, 1196032
    buffer_load_dword v202, v12, s[40:43], s3 offen sc1
    s_add_u32 s3, s64, 1204224
    buffer_load_dword v203, v12, s[40:43], s3 offen sc1
    s_add_u32 s3, s64, 1179712
    buffer_load_dword v204, v12, s[40:43], s3 offen sc1
    s_add_u32 s3, s64, 1187904
    buffer_load_dword v205, v12, s[40:43], s3 offen sc1
    s_add_u32 s3, s64, 1196096
    buffer_load_dword v206, v12, s[40:43], s3 offen sc1
    s_add_u32 s3, s64, 1204288
    buffer_load_dword v207, v12, s[40:43], s3 offen sc1
    s_waitcnt vmcnt(0)
    v_max3_u32 v12, v192, v193, v194
    v_max3_u32 v13, v195, v196, v197
    v_max3_u32 v12, v12, v198, v199
    v_max3_u32 v13, v13, v200, v201
    v_max3_u32 v12, v12, v202, v203
    v_max3_u32 v13, v13, v204, v205
    v_max3_u32 v12, v12, v206, v207
    v_max_u32 v12, v12, v13
    v_cmp_eq_u32 vcc, -1, v12
    s_cbranch_vccnz L_tk4_retry
    s_branch L_tk4_ok
L_tk5_retry:
    s_add_u32 s69, s69, 1
    s_cmp_gt_u32 s69, 262144
    s_cbranch_scc1 L_tk5_ok
    v_and_b32 v12, 15, v1
    v_lshlrev_b32 v12, 2, v12
    v_lshrrev_b32 v13, 4, v1
    v_lshl_add_u32 v12, v13, 15, v12
    s_add_u32 s3, s64, 1310720
    buffer_load_dword v208, v12, s[40:43], s3 offen sc1
    s_add_u32 s3, s64, 1318912
    buffer_load_dword v209, v12, s[40:43], s3 offen sc1
    s_add_u32 s3, s64, 1327104
    buffer_load_dword v210, v12, s[40:43], s3 offen sc1
    s_add_u32 s3, s64, 1335296
    buffer_load_dword v211, v12, s[40:43], s3 offen sc1
    s_add_u32 s3, s64, 1310784
    buffer_load_dword v212, v12, s[40:43], s3 offen sc1
    s_add_u32 s3, s64, 1318976
    buffer_load_dword v213, v12, s[40:43], s3 offen sc1
    s_add_u32 s3, s64, 1327168
    buffer_load_dword v214, v12, s[40:43], s3 offen sc1
    s_add_u32 s3, s64, 1335360
    buffer_load_dword v215, v12, s[40:43], s3 offen sc1
    s_add_u32 s3, s64, 1441792
    buffer_load_dword v216, v12, s[40:43], s3 offen sc1
    s_add_u32 s3, s64, 1449984
    buffer_load_dword v217, v12, s[40:43], s3 offen sc1
    s_add_u32 s3, s64, 1458176
    buffer_load_dword v218, v12, s[40:43], s3 offen sc1
    s_add_u32 s3, s64, 1466368
    buffer_load_dword v219, v12, s[40:43], s3 offen sc1
    s_add_u32 s3, s64, 1441856
    buffer_load_dword v220, v12, s[40:43], s3 offen sc1
    s_add_u32 s3, s64, 1450048
    buffer_load_dword v221, v12, s[40:43], s3 offen sc1
    s_add_u32 s3, s64, 1458240
    buffer_load_dword v222, v12, s[40:43], s3 offen sc1
    s_add_u32 s3, s64, 1466432
    buffer_load_dword v223, v12, s[40:43], s3 offen sc1
    s_waitcnt vmcnt(0)
    v_max3_u32 v12, v208, v209, v210
    v_max3_u32 v13, v211, v212, v213
    v_max3_u32 v12, v12, v214, v215
    v_max3_u32 v13, v13, v216, v217
    v_max3_u32 v12, v12, v218, v219
    v_max3_u32 v13, v13, v220, v221
    v_max3_u32 v12, v12, v222, v223
    v_max_u32 v12, v12, v13
    v_cmp_eq_u32 vcc, -1, v12
    s_cbranch_vccnz L_tk5_retry
    s_branch L_tk5_ok
L_tk6_retry:
    s_add_u32 s69, s69, 1
    s_cmp_gt_u32 s69, 262144
    s_cbranch_scc1 L_tk6_ok
    v_and_b32 v12, 15, v1
    v_lshlrev_b32 v12, 2, v12
    v_lshrrev_b32 v13, 4, v1
    v_lshl_add_u32 v12, v13, 15, v12
    s_add_u32 s3, s64, 1572864
    buffer_load_dword v224, v12, s[40:43], s3 offen sc1
    s_add_u32 s3, s64, 1581056
    buffer_load_dword v225, v12, s[40:43], s3 offen sc1
    s_add_u32 s3, s64, 1589248
    buffer_load_dword v226, v12, s[40:43], s3 offen sc1
    s_add_u32 s3, s64, 1597440
    buffer_load_dword v227, v12, s[40:43], s3 offen sc1
    s_add_u32 s3, s64, 1572928
    buffer_load_dword v228, v12, s[40:43], s3 offen sc1
    s_add_u32 s3, s64, 1581120
    buffer_load_dword v229, v12, s[40:43], s3 offen sc1
    s_add_u32 s3, s64, 1589312
    buffer_load_dword v230, v12, s[40:43], s3 offen sc1
    s_add_u32 s3, s64, 1597504
    buffer_load_dword v231, v12, s[40:43], s3 offen sc1
    s_add_u32 s3, s64, 1703936
    buffer_load_dword v232, v12, s[40:43], s3 offen sc1
    s_add_u32 s3, s64, 1712128
    buffer_load_dword v233, v12, s[40:43], s3 offen sc1
    s_add_u32 s3, s64, 1720320
    buffer_load_dword v234, v12, s[40:43], s3 offen sc1
    s_add_u32 s3, s64, 1728512
    buffer_load_dword v235, v12, s[40:43], s3 offen sc1
    s_add_u32 s3, s64, 1704000
    buffer_load_dword v236, v12, s[40:43], s3 offen sc1
    s_add_u32 s3, s64, 1712192
    buffer_load_dword v237, v12, s[40:43], s3 offen sc1
    s_add_u32 s3, s64, 1720384
    buffer_load_dword v238, v12, s[40:43], s3 offen sc1
    s_add_u32 s3, s64, 1728576
    buffer_load_dword v239, v12, s[40:43], s3 offen sc1
    s_waitcnt vmcnt(0)
    v_max3_u32 v12, v224, v225, v226
    v_max3_u32 v13, v227, v228, v229
    v_max3_u32 v12, v12, v230, v231
    v_max3_u32 v13, v13, v232, v233
    v_max3_u32 v12, v12, v234, v235
    v_max3_u32 v13, v13, v236, v237
    v_max3_u32 v12, v12, v238, v239
    v_max_u32 v12, v12, v13
    v_cmp_eq_u32 vcc, -1, v12
    s_cbranch_vccnz L_tk6_retry
    s_branch L_tk6_ok
L_tk7_retry:
    s_add_u32 s69, s69, 1
    s_cmp_gt_u32 s69, 262144
    s_cbranch_scc1 L_tk7_ok
    v_and_b32 v12, 15, v1
    v_lshlrev_b32 v12, 2, v12
    v_lshrrev_b32 v13, 4, v1
    v_lshl_add_u32 v12, v13, 15, v12
    s_add_u32 s3, s64, 1835008
    buffer_load_dword v240, v12, s[40:43], s3 offen sc1
    s_add_u32 s3, s64, 1843200
    buffer_load_dword v241, v12, s[40:43], s3 offen sc1
    s_add_u32 s3, s64, 1851392
    buffer_load_dword v242, v12, s[40:43], s3 offen sc1
    s_add_u32 s3, s64, 1859584
    buffer_load_dword v243, v12, s[40:43], s3 offen sc1
    s_add_u32 s3, s64, 1835072
    buffer_load_dword v244, v12, s[40:43], s3 offen sc1
    s_add_u32 s3, s64, 1843264
    buffer_load_dword v245, v12, s[40:43], s3 offen sc1
    s_add_u32 s3, s64, 1851456
    buffer_load_dword v246, v12, s[40:43], s3 offen sc1
    s_add_u32 s3, s64, 1859648
    buffer_load_dword v247, v12, s[40:43], s3 offen sc1
    s_add_u32 s3, s64, 1966080
    buffer_load_dword v248, v12, s[40:43], s3 offen sc1
    s_add_u32 s3, s64, 1974272
    buffer_load_dword v249, v12, s[40:43], s3 offen sc1
    s_add_u32 s3, s64, 1982464
    buffer_load_dword v250, v12, s[40:43], s3 offen sc1
    s_add_u32 s3, s64, 1990656
    buffer_load_dword v251, v12, s[40:43], s3 offen sc1
    s_add_u32 s3, s64, 1966144
    buffer_load_dword v252, v12, s[40:43], s3 offen sc1
    s_add_u32 s3, s64, 1974336
    buffer_load_dword v253, v12, s[40:43], s3 offen sc1
    s_add_u32 s3, s64, 1982528
    buffer_load_dword v254, v12, s[40:43], s3 offen sc1
    s_add_u32 s3, s64, 1990720
    buffer_load_dword v255, v12, s[40:43], s3 offen sc1
    s_waitcnt vmcnt(0)
    v_max3_u32 v12, v240, v241, v242
    v_max3_u32 v13, v243, v244, v245
    v_max3_u32 v12, v12, v246, v247
    v_max3_u32 v13, v13, v248, v249
    v_max3_u32 v12, v12, v250, v251
    v_max3_u32 v13, v13, v252, v253
    v_max3_u32 v12, v12, v254, v255
    v_max_u32 v12, v12, v13
    v_cmp_eq_u32 vcc, -1, v12
    s_cbranch_vccnz L_tk7_retry
    s_branch L_tk7_ok
L_pf_retry:
    s_add_u32 s69, s69, 1
    s_cmp_gt_u32 s69, 262144
    s_cbranch_scc1 L_pf_ok
    buffer_load_dword v17, v16, s[40:43], s47 offen sc1
    s_waitcnt vmcnt(0)
    v_cmp_ne_u32 vcc, s5, v17
    s_cbranch_vccnz L_pf_retry
    s_branch L_pf_ok
L_csc_retry:
    s_add_u32 s69, s69, 1
    s_cmp_gt_u32 s69, 262144
    s_cbranch_scc1 L_csc_ok
    buffer_load_dwordx2 v[16:17], v4, s[40:43], s57 offen sc1
    buffer_load_dwordx2 v[18:19], v5, s[40:43], s57 offen sc1
    buffer_load_dwordx2 v[20:21], v4, s[40:43], s58 offen sc1
    buffer_load_dwordx2 v[22:23], v5, s[40:43], s58 offen sc1
    s_waitcnt vmcnt(0)
    v_xor_b32 v17, s5, v17
    v_xor_b32 v19, s5, v19
    v_xor_b32 v21, s5, v21
    v_xor_b32 v23, s5, v23
    v_or3_b32 v17, v17, v19, v21
    v_or_b32 v17, v17, v23
    v_cmp_ne_u32 vcc, 0, v17
    s_cbranch_vccnz L_csc_retry
    s_branch L_csc_ok
L_hh0_retry:
    s_add_u32 s69, s69, 1
    s_cmp_gt_u32 s69, 262144
    s_cbranch_scc1 L_hh0_ok
    buffer_load_dwordx4 v[16:19], v8, s[40:43], s48 offen offset:0 sc1
    buffer_load_dwordx4 v[20:23], v9, s[40:43], s48 offen offset:0 sc1
    buffer_load_dwordx4 v[24:27], v8, s[40:43], s49 offen offset:0 sc1
    buffer_load_dwordx4 v[28:31], v9, s[40:43], s49 offen offset:0 sc1
    s_waitcnt vmcnt(0)
    v_xor_b32 v16, v7, v16
    v_xor_b32 v17, v7, v17
    v_xor_b32 v18, v7, v18
    v_or3_b32 v2, v16, v17, v18
    v_xor_b32 v19, v7, v19
    v_xor_b32 v20, v7, v20
    v_or3_b32 v2, v2, v19, v20
    v_xor_b32 v21, v7, v21
    v_xor_b32 v22, v7, v22
    v_or3_b32 v2, v2, v21, v22
    v_xor_b32 v23, v7, v23
    v_xor_b32 v24, v7, v24
    v_or3_b32 v2, v2, v23, v24
    v_xor_b32 v25, v7, v25
    v_xor_b32 v26, v7, v26
    v_or3_b32 v2, v2, v25, v26
    v_xor_b32 v27, v7, v27
    v_xor_b32 v28, v7, v28
    v_or3_b32 v2, v2, v27, v28
    v_xor_b32 v29, v7, v29
    v_xor_b32 v30, v7, v30
    v_or3_b32 v2, v2, v29, v30
    v_xor_b32 v31, v7, v31
    v_bitop3_b32 v2, v2, v31, s68 bitop3:0xa8
    v_cmp_ne_u32 vcc, 0, v2
    s_cbranch_vccnz L_hh0_retry
    s_branch L_hh0_ok
L_hh2_retry:
    s_add_u32 s69, s69, 1
    s_cmp_gt_u32 s69, 262144
    s_cbranch_scc1 L_hh2_ok
    buffer_load_dwordx4 v[32:35], v8, s[40:43], s50 offen offset:0 sc1
    buffer_load_dwordx4 v[36:39], v9, s[40:43], s50 offen offset:0 sc1
    buffer_load_dwordx4 v[40:43], v8, s[40:43], s51 offen offset:0 sc1
    buffer_load_dwordx4 v[44:47], v9, s[40:43], s51 offen offset:0 sc1
    s_waitcnt vmcnt(0)
    v_xor_b32 v32, v7, v32
    v_xor_b32 v33, v7, v33
    v_xor_b32 v34, v7, v34
    v_or3_b32 v2, v32, v33, v34
    v_xor_b32 v35, v7, v35
    v_xor_b32 v36, v7, v36
    v_or3_b32 v2, v2, v35, v36
    v_xor_b32 v37, v7, v37
    v_xor_b32 v38, v7, v38
    v_or3_b32 v2, v2, v37, v38
    v_xor_b32 v39, v7, v39
    v_xor_b32 v40, v7, v40
    v_or3_b32 v2, v2, v39, v40
    v_xor_b32 v41, v7, v41
    v_xor_b32 v42, v7, v42
    v_or3_b32 v2, v2, v41, v42
    v_xor_b32 v43, v7, v43
    v_xor_b32 v44, v7, v44
    v_or3_b32 v2, v2, v43, v44
    v_xor_b32 v45, v7, v45
    v_xor_b32 v46, v7, v46
    v_or3_b32 v2, v2, v45, v46
    v_xor_b32 v47, v7, v47
    v_bitop3_b32 v2, v2, v47, s68 bitop3:0xa8
    v_cmp_ne_u32 vcc, 0, v2
    s_cbranch_vccnz L_hh2_retry
    s_branch L_hh2_ok
L_hh4_retry:
    s_add_u32 s69, s69, 1
    s_cmp_gt_u32 s69, 262144
    s_cbranch_scc1 L_hh4_ok
    buffer_load_dwordx4 v[48:51], v8, s[40:43], s48 offen offset:1024 sc1
    buffer_load_dwordx4 v[52:55], v9, s[40:43], s48 offen offset:1024 sc1
    buffer_load_dwordx4 v[128:131], v8, s[40:43], s49 offen offset:1024 sc1
    buffer_load_dwordx4 v[132:135], v9, s[40:43], s49 offen offset:1024 sc1
    s_waitcnt vmcnt(0)
    v_xor_b32 v48, v7, v48
    v_xor_b32 v49, v7, v49
    v_xor_b32 v50, v7, v50
    v_or3_b32 v2, v48, v49, v50
    v_xor_b32 v51, v7, v51
    v_xor_b32 v52, v7, v52
    v_or3_b32 v2, v2, v51, v52
    v_xor_b32 v53, v7, v53
    v_xor_b32 v54, v7, v54
    v_or3_b32 v2, v2, v53, v54
    v_xor_b32 v55, v7, v55
    v_xor_b32 v128, v7, v128
    v_or3_b32 v2, v2, v55, v128
    v_xor_b32 v129, v7, v129
    v_xor_b32 v130, v7, v130
    v_or3_b32 v2, v2, v129, v130
    v_xor_b32 v131, v7, v131
    v_xor_b32 v132, v7, v132
    v_or3_b32 v2, v2, v131, v132
    v_xor_b32 v133, v7, v133
    v_xor_b32 v134, v7, v134
    v_or3_b32 v2, v2, v133, v134
    v_xor_b32 v135, v7, v135
    v_bitop3_b32 v2, v2, v135, s68 bitop3:0xa8
    v_cmp_ne_u32 vcc, 0, v2
    s_cbranch_vccnz L_hh4_retry
    s_branch L_hh4_ok
L_hh6_retry:
    s_add_u32 s69, s69, 1
    s_cmp_gt_u32 s69, 262144
    s_cbranch_scc1 L_hh6_ok
    buffer_load_dwordx4 v[32:35], v8, s[40:43], s50 offen offset:1024 sc1
    buffer_load_dwordx4 v[36:39], v9, s[40:43], s50 offen offset:1024 sc1
    buffer_load_dwordx4 v[40:43], v8, s[40:43], s51 offen offset:1024 sc1
    buffer_load_dwordx4 v[44:47], v9, s[40:43], s51 offen offset:1024 sc1
    s_waitcnt vmcnt(0)
    v_xor_b32 v32, v7, v32
    v_xor_b32 v33, v7, v33
    v_xor_b32 v34, v7, v34
    v_or3_b32 v2, v32, v33, v34
    v_xor_b32 v35, v7, v35
    v_xor_b32 v36, v7, v36
    v_or3_b32 v2, v2, v35, v36
    v_xor_b32 v37, v7, v37
    v_xor_b32 v38, v7, v38
    v_or3_b32 v2, v2, v37, v38
    v_xor_b32 v39, v7, v39
    v_xor_b32 v40, v7, v40
    v_or3_b32 v2, v2, v39, v40
    v_xor_b32 v41, v7, v41
    v_xor_b32 v42, v7, v42
    v_or3_b32 v2, v2, v41, v42
    v_xor_b32 v43, v7, v43
    v_xor_b32 v44, v7, v44
    v_or3_b32 v2, v2, v43, v44
    v_xor_b32 v45, v7, v45
    v_xor_b32 v46, v7, v46
    v_or3_b32 v2, v2, v45, v46
    v_xor_b32 v47, v7, v47
    v_bitop3_b32 v2, v2, v47, s68 bitop3:0xa8
    v_cmp_ne_u32 vcc, 0, v2
    s_cbranch_vccnz L_hh6_retry
    s_branch L_hh6_ok
L_hh8_retry:
    s_add_u32 s69, s69, 1
    s_cmp_gt_u32 s69, 262144
    s_cbranch_scc1 L_hh8_ok
    buffer_load_dwordx4 v[48:51], v8, s[40:43], s48 offen offset:2048 sc1
    buffer_load_dwordx4 v[52:55], v9, s[40:43], s48 offen offset:2048 sc1
    buffer_load_dwordx4 v[128:131], v8, s[40:43], s49 offen offset:2048 sc1
    buffer_load_dwordx4 v[132:135], v9, s[40:43], s49 offen offset:2048 sc1
    s_waitcnt vmcnt(0)
    v_xor_b32 v48, v7, v48
    v_xor_b32 v49, v7, v49
    v_xor_b32 v50, v7, v50
    v_or3_b32 v2, v48, v49, v50
    v_xor_b32 v51, v7, v51
    v_xor_b32 v52, v7, v52
    v_or3_b32 v2, v2, v51, v52
    v_xor_b32 v53, v7, v53
    v_xor_b32 v54, v7, v54
    v_or3_b32 v2, v2, v53, v54
    v_xor_b32 v55, v7, v55
    v_xor_b32 v128, v7, v128
    v_or3_b32 v2, v2, v55, v128
    v_xor_b32 v129, v7, v129
    v_xor_b32 v130, v7, v130
    v_or3_b32 v2, v2, v129, v130
    v_xor_b32 v131, v7, v131
    v_xor_b32 v132, v7, v132
    v_or3_b32 v2, v2, v131, v132
    v_xor_b32 v133, v7, v133
    v_xor_b32 v134, v7, v134
    v_or3_b32 v2, v2, v133, v134
    v_xor_b32 v135, v7, v135
    v_bitop3_b32 v2, v2, v135, s68 bitop3:0xa8
    v_cmp_ne_u32 vcc, 0, v2
    s_cbranch_vccnz L_hh8_retry
    s_branch L_hh8_ok
L_hh10_retry:
    s_add_u32 s69, s69, 1
    s_cmp_gt_u32 s69, 262144
    s_cbranch_scc1 L_hh10_ok
    buffer_load_dwordx4 v[32:35], v8, s[40:43], s50 offen offset:2048 sc1
    buffer_load_dwordx4 v[36:39], v9, s[40:43], s50 offen offset:2048 sc1
    buffer_load_dwordx4 v[40:43], v8, s[40:43], s51 offen offset:2048 sc1
    buffer_load_dwordx4 v[44:47], v9, s[40:43], s51 offen offset:2048 sc1
    s_waitcnt vmcnt(0)
    v_xor_b32 v32, v7, v32
    v_xor_b32 v33, v7, v33
    v_xor_b32 v34, v7, v34
    v_or3_b32 v2, v32, v33, v34
    v_xor_b32 v35, v7, v35
    v_xor_b32 v36, v7, v36
    v_or3_b32 v2, v2, v35, v36
    v_xor_b32 v37, v7, v37
    v_xor_b32 v38, v7, v38
    v_or3_b32 v2, v2, v37, v38
    v_xor_b32 v39, v7, v39
    v_xor_b32 v40, v7, v40
    v_or3_b32 v2, v2, v39, v40
    v_xor_b32 v41, v7, v41
    v_xor_b32 v42, v7, v42
    v_or3_b32 v2, v2, v41, v42
    v_xor_b32 v43, v7, v43
    v_xor_b32 v44, v7, v44
    v_or3_b32 v2, v2, v43, v44
    v_xor_b32 v45, v7, v45
    v_xor_b32 v46, v7, v46
    v_or3_b32 v2, v2, v45, v46
    v_xor_b32 v47, v7, v47
    v_bitop3_b32 v2, v2, v47, s68 bitop3:0xa8
    v_cmp_ne_u32 vcc, 0, v2
    s_cbranch_vccnz L_hh10_retry
    s_branch L_hh10_ok
L_hh12_retry:
    s_add_u32 s69, s69, 1
    s_cmp_gt_u32 s69, 262144
    s_cbranch_scc1 L_hh12_ok
    buffer_load_dwordx4 v[48:51], v8, s[40:43], s48 offen offset:3072 sc1
    buffer_load_dwordx4 v[52:55], v9, s[40:43], s48 offen offset:3072 sc1
    buffer_load_dwordx4 v[120:123], v8, s[40:43], s49 offen offset:3072 sc1
    buffer_load_dwordx4 v[124:127], v9, s[40:43], s49 offen offset:3072 sc1
    s_waitcnt vmcnt(0)
    v_xor_b32 v48, v7, v48
    v_xor_b32 v49, v7, v49
    v_xor_b32 v50, v7, v50
    v_or3_b32 v2, v48, v49, v50
    v_xor_b32 v51, v7, v51
    v_xor_b32 v52, v7, v52
    v_or3_b32 v2, v2, v51, v52
    v_xor_b32 v53, v7, v53
    v_xor_b32 v54, v7, v54
    v_or3_b32 v2, v2, v53, v54
    v_xor_b32 v55, v7, v55
    v_xor_b32 v120, v7, v120
    v_or3_b32 v2, v2, v55, v120
    v_xor_b32 v121, v7, v121
    v_xor_b32 v122, v7, v122
    v_or3_b32 v2, v2, v121, v122
    v_xor_b32 v123, v7, v123
    v_xor_b32 v124, v7, v124
    v_or3_b32 v2, v2, v123, v124
    v_xor_b32 v125, v7, v125
    v_xor_b32 v126, v7, v126
    v_or3_b32 v2, v2, v125, v126
    v_xor_b32 v127, v7, v127
    v_bitop3_b32 v2, v2, v127, s68 bitop3:0xa8
    v_cmp_ne_u32 vcc, 0, v2
    s_cbranch_vccnz L_hh12_retry
    s_branch L_hh12_ok
L_hh14_retry:
    s_add_u32 s69, s69, 1
    s_cmp_gt_u32 s69, 262144
    s_cbranch_scc1 L_hh14_ok
    buffer_load_dwordx4 v[136:139], v8, s[40:43], s50 offen offset:3072 sc1
    buffer_load_dwordx4 v[140:143], v9, s[40:43], s50 offen offset:3072 sc1
    buffer_load_dwordx4 v[144:147], v8, s[40:43], s51 offen offset:3072 sc1
    buffer_load_dwordx4 v[148:151], v9, s[40:43], s51 offen offset:3072 sc1
    s_waitcnt vmcnt(0)
    v_xor_b32 v136, v7, v136
    v_xor_b32 v137, v7, v137
    v_xor_b32 v138, v7, v138
    v_or3_b32 v2, v136, v137, v138
    v_xor_b32 v139, v7, v139
    v_xor_b32 v140, v7, v140
    v_or3_b32 v2, v2, v139, v140
    v_xor_b32 v141, v7, v141
    v_xor_b32 v142, v7, v142
    v_or3_b32 v2, v2, v141, v142
    v_xor_b32 v143, v7, v143
    v_xor_b32 v144, v7, v144
    v_or3_b32 v2, v2, v143, v144
    v_xor_b32 v145, v7, v145
    v_xor_b32 v146, v7, v146
    v_or3_b32 v2, v2, v145, v146
    v_xor_b32 v147, v7, v147
    v_xor_b32 v148, v7, v148
    v_or3_b32 v2, v2, v147, v148
    v_xor_b32 v149, v7, v149
    v_xor_b32 v150, v7, v150
    v_or3_b32 v2, v2, v149, v150
    v_xor_b32 v151, v7, v151
    v_bitop3_b32 v2, v2, v151, s68 bitop3:0xa8
    v_cmp_ne_u32 vcc, 0, v2
    s_cbranch_vccnz L_hh14_retry
    s_branch L_hh14_ok
L_hh16_retry:
    s_add_u32 s69, s69, 1
    s_cmp_gt_u32 s69, 262144
    s_cbranch_scc1 L_hh16_ok
    buffer_load_dwordx4 v[152:155], v8, s[40:43], s44 offen offset:0 sc1
    buffer_load_dwordx4 v[156:159], v9, s[40:43], s44 offen offset:0 sc1
    buffer_load_dwordx4 v[160:163], v8, s[40:43], s45 offen offset:0 sc1
    buffer_load_dwordx4 v[164:167], v9, s[40:43], s45 offen offset:0 sc1
    s_waitcnt vmcnt(0)
    v_xor_b32 v152, v7, v152
    v_xor_b32 v153, v7, v153
    v_xor_b32 v154, v7, v154
    v_or3_b32 v2, v152, v153, v154
    v_xor_b32 v155, v7, v155
    v_xor_b32 v156, v7, v156
    v_or3_b32 v2, v2, v155, v156
    v_xor_b32 v157, v7, v157
    v_xor_b32 v158, v7, v158
    v_or3_b32 v2, v2, v157, v158
    v_xor_b32 v159, v7, v159
    v_xor_b32 v160, v7, v160
    v_or3_b32 v2, v2, v159, v160
    v_xor_b32 v161, v7, v161
    v_xor_b32 v162, v7, v162
    v_or3_b32 v2, v2, v161, v162
    v_xor_b32 v163, v7, v163
    v_xor_b32 v164, v7, v164
    v_or3_b32 v2, v2, v163, v164
    v_xor_b32 v165, v7, v165
    v_xor_b32 v166, v7, v166
    v_or3_b32 v2, v2, v165, v166
    v_xor_b32 v167, v7, v167
    v_bitop3_b32 v2, v2, v167, s68 bitop3:0xa8
    v_cmp_ne_u32 vcc, 0, v2
    s_cbranch_vccnz L_hh16_retry
    s_branch L_hh16_ok
L_hh18_retry:
    s_add_u32 s69, s69, 1
    s_cmp_gt_u32 s69, 262144
    s_cbranch_scc1 L_hh18_ok
    buffer_load_dwordx4 v[168:171], v8, s[40:43], s46 offen offset:0 sc1
    buffer_load_dwordx4 v[172:175], v9, s[40:43], s46 offen offset:0 sc1
    buffer_load_dwordx4 v[176:179], v8, s[40:43], s47 offen offset:0 sc1
    buffer_load_dwordx4 v[180:183], v9, s[40:43], s47 offen offset:0 sc1
    s_waitcnt vmcnt(0)
    v_xor_b32 v168, v7, v168
    v_xor_b32 v169, v7, v169
    v_xor_b32 v170, v7, v170
    v_or3_b32 v2, v168, v169, v170
    v_xor_b32 v171, v7, v171
    v_xor_b32 v172, v7, v172
    v_or3_b32 v2, v2, v171, v172
    v_xor_b32 v173, v7, v173
    v_xor_b32 v174, v7, v174
    v_or3_b32 v2, v2, v173, v174
    v_xor_b32 v175, v7, v175
    v_xor_b32 v176, v7, v176
    v_or3_b32 v2, v2, v175, v176
    v_xor_b32 v177, v7, v177
    v_xor_b32 v178, v7, v178
    v_or3_b32 v2, v2, v177, v178
    v_xor_b32 v179, v7, v179
    v_xor_b32 v180, v7, v180
    v_or3_b32 v2, v2, v179, v180
    v_xor_b32 v181, v7, v181
    v_xor_b32 v182, v7, v182
    v_or3_b32 v2, v2, v181, v182
    v_xor_b32 v183, v7, v183
    v_bitop3_b32 v2, v2, v183, s68 bitop3:0xa8
    v_cmp_ne_u32 vcc, 0, v2
    s_cbranch_vccnz L_hh18_retry
    s_branch L_hh18_ok
L_hh20_retry:
    s_add_u32 s69, s69, 1
    s_cmp_gt_u32 s69, 262144
    s_cbranch_scc1 L_hh20_ok
    buffer_load_dwordx4 v[184:187], v8, s[40:43], s44 offen offset:1024 sc1
    buffer_load_dwordx4 v[188:191], v9, s[40:43], s44 offen offset:1024 sc1
    buffer_load_dwordx4 v[128:131], v8, s[40:43], s45 offen offset:1024 sc1
    buffer_load_dwordx4 v[132:135], v9, s[40:43], s45 offen offset:1024 sc1
    s_waitcnt vmcnt(0)
    v_xor_b32 v184, v7, v184
    v_xor_b32 v185, v7, v185
    v_xor_b32 v186, v7, v186
    v_or3_b32 v2, v184, v185, v186
    v_xor_b32 v187, v7, v187
    v_xor_b32 v188, v7, v188
    v_or3_b32 v2, v2, v187, v188
    v_xor_b32 v189, v7, v189
    v_xor_b32 v190, v7, v190
    v_or3_b32 v2, v2, v189, v190
    v_xor_b32 v191, v7, v191
    v_xor_b32 v128, v7, v128
    v_or3_b32 v2, v2, v191, v128
    v_xor_b32 v129, v7, v129
    v_xor_b32 v130, v7, v130
    v_or3_b32 v2, v2, v129, v130
    v_xor_b32 v131, v7, v131
    v_xor_b32 v132, v7, v132
    v_or3_b32 v2, v2, v131, v132
    v_xor_b32 v133, v7, v133
    v_xor_b32 v134, v7, v134
    v_or3_b32 v2, v2, v133, v134
    v_xor_b32 v135, v7, v135
    v_bitop3_b32 v2, v2, v135, s68 bitop3:0xa8
    v_cmp_ne_u32 vcc, 0, v2
    s_cbranch_vccnz L_hh20_retry
    s_branch L_hh20_ok
L_hh22_retry:
    s_add_u32 s69, s69, 1
    s_cmp_gt_u32 s69, 262144
    s_cbranch_scc1 L_hh22_ok
    buffer_load_dwordx4 v[192:195], v8, s[40:43], s46 offen offset:1024 sc1
    buffer_load_dwordx4 v[196:199], v9, s[40:43], s46 offen offset:1024 sc1
    buffer_load_dwordx4 v[32:35], v8, s[40:43], s47 offen offset:1024 sc1
    buffer_load_dwordx4 v[36:39], v9, s[40:43], s47 offen offset:1024 sc1
    s_waitcnt vmcnt(0)
    v_xor_b32 v192, v7, v192
    v_xor_b32 v193, v7, v193
    v_xor_b32 v194, v7, v194
    v_or3_b32 v2, v192, v193, v194
    v_xor_b32 v195, v7, v195
    v_xor_b32 v196, v7, v196
    v_or3_b32 v2, v2, v195, v196
    v_xor_b32 v197, v7, v197
    v_xor_b32 v198, v7, v198
    v_or3_b32 v2, v2, v197, v198
    v_xor_b32 v199, v7, v199
    v_xor_b32 v32, v7, v32
    v_or3_b32 v2, v2, v199, v32
    v_xor_b32 v33, v7, v33
    v_xor_b32 v34, v7, v34
    v_or3_b32 v2, v2, v33, v34
    v_xor_b32 v35, v7, v35
    v_xor_b32 v36, v7, v36
    v_or3_b32 v2, v2, v35, v36
    v_xor_b32 v37, v7, v37
    v_xor_b32 v38, v7, v38
    v_or3_b32 v2, v2, v37, v38
    v_xor_b32 v39, v7, v39
    v_bitop3_b32 v2, v2, v39, s68 bitop3:0xa8
    v_cmp_ne_u32 vcc, 0, v2
    s_cbranch_vccnz L_hh22_retry
    s_branch L_hh22_ok
L_hh24_retry:
    s_add_u32 s69, s69, 1
    s_cmp_gt_u32 s69, 262144
    s_cbranch_scc1 L_hh24_ok
    buffer_load_dwordx4 v[200:203], v8, s[40:43], s44 offen offset:2048 sc1
    buffer_load_dwordx4 v[204:207], v9, s[40:43], s44 offen offset:2048 sc1
    buffer_load_dwordx4 v[40:43], v8, s[40:43], s45 offen offset:2048 sc1
    buffer_load_dwordx4 v[44:47], v9, s[40:43], s45 offen offset:2048 sc1
    s_waitcnt vmcnt(0)
    v_xor_b32 v200, v7, v200
    v_xor_b32 v201, v7, v201
    v_xor_b32 v202, v7, v202
    v_or3_b32 v2, v200, v201, v202
    v_xor_b32 v203, v7, v203
    v_xor_b32 v204, v7, v204
    v_or3_b32 v2, v2, v203, v204
    v_xor_b32 v205, v7, v205
    v_xor_b32 v206, v7, v206
    v_or3_b32 v2, v2, v205, v206
    v_xor_b32 v207, v7, v207
    v_xor_b32 v40, v7, v40
    v_or3_b32 v2, v2, v207, v40
    v_xor_b32 v41, v7, v41
    v_xor_b32 v42, v7, v42
    v_or3_b32 v2, v2, v41, v42
    v_xor_b32 v43, v7, v43
    v_xor_b32 v44, v7, v44
    v_or3_b32 v2, v2, v43, v44
    v_xor_b32 v45, v7, v45
    v_xor_b32 v46, v7, v46
    v_or3_b32 v2, v2, v45, v46
    v_xor_b32 v47, v7, v47
    v_bitop3_b32 v2, v2, v47, s68 bitop3:0xa8
    v_cmp_ne_u32 vcc, 0, v2
    s_cbranch_vccnz L_hh24_retry
    s_branch L_hh24_ok
L_hh26_retry:
    s_add_u32 s69, s69, 1
    s_cmp_gt_u32 s69, 262144
    s_cbranch_scc1 L_hh26_ok
    buffer_load_dwordx4 v[208:211], v8, s[40:43], s46 offen offset:2048 sc1
    buffer_load_dwordx4 v[212:215], v9, s[40:43], s46 offen offset:2048 sc1
    buffer_load_dwordx4 v[48:51], v8, s[40:43], s47 offen offset:2048 sc1
    buffer_load_dwordx4 v[52:55], v9, s[40:43], s47 offen offset:2048 sc1
    s_waitcnt vmcnt(0)
    v_xor_b32 v208, v7, v208
    v_xor_b32 v209, v7, v209
    v_xor_b32 v210, v7, v210
    v_or3_b32 v2, v208, v209, v210
    v_xor_b32 v211, v7, v211
    v_xor_b32 v212, v7, v212
    v_or3_b32 v2, v2, v211, v212
    v_xor_b32 v213, v7, v213
    v_xor_b32 v214, v7, v214
    v_or3_b32 v2, v2, v213, v214
    v_xor_b32 v215, v7, v215
    v_xor_b32 v48, v7, v48
    v_or3_b32 v2, v2, v215, v48
    v_xor_b32 v49, v7, v49
    v_xor_b32 v50, v7, v50
    v_or3_b32 v2, v2, v49, v50
    v_xor_b32 v51, v7, v51
    v_xor_b32 v52, v7, v52
    v_or3_b32 v2, v2, v51, v52
    v_xor_b32 v53, v7, v53
    v_xor_b32 v54, v7, v54
    v_or3_b32 v2, v2, v53, v54
    v_xor_b32 v55, v7, v55
    v_bitop3_b32 v2, v2, v55, s68 bitop3:0xa8
    v_cmp_ne_u32 vcc, 0, v2
    s_cbranch_vccnz L_hh26_retry
    s_branch L_hh26_ok
L_exit:
    s_endpgm
L_end_k:
.section .rodata,"a"
.p2align 6
.amdhsa_kernel sequential_preLN__ssm_conv_s4__glu_gated_bilinear__prompt_kernel
  .amdhsa_next_free_vgpr 256
  .amdhsa_next_free_sgpr 102
  .amdhsa_accum_offset 256
  .amdhsa_group_segment_fixed_size 0
  .amdhsa_kernarg_size 128
  .amdhsa_user_sgpr_count 2
  .amdhsa_user_sgpr_kernarg_segment_ptr 1
  .amdhsa_system_sgpr_workgroup_id_x 1
.end_amdhsa_kernel
```
